```python
import torch

def _softmax(x, axis=-1):
    return torch.softmax(x, dim=axis)

def _gelu(x):
    return torch.nn.functional.gelu(x, approximate='tanh')

def _silu(x):
    return torch.nn.functional.silu(x)

def _sigmoid(x):
    return torch.sigmoid(x)

def _layernorm(x, axis=-1, eps=1e-05):
    m = x.mean(dim=axis, keepdim=True)
    v = x.var(dim=axis, keepdim=True, unbiased=False)
    return (x - m) / torch.sqrt(v + eps)

def _scatter_add(tgt, idx, src, axis=0):
    return tgt.clone().index_add_(axis, idx, src)

def _segment_sum(src, seg, n):
    out = torch.zeros((n,) + src.shape[1:], dtype=src.dtype)
    return out.index_add_(0, seg, src)

def _pad(x, pw):
    flat = tuple((v for pair in reversed(pw) for v in pair))
    return torch.nn.functional.pad(x, flat)
kernel_name = 'standalone__tree_speculative_verify_tree_attention_over_candidate_token_tree__decode'

def setup_inputs():

    _w = lambda a: (lambda t: t.to(torch.bfloat16) if t.is_floating_point() else t)(torch.as_tensor(a))
    B, Hq, Hkv, T, C, D = (2, 32, 4, 1, 32768, 128)
    tree_mask = torch.zeros((B, T, T), dtype=float)
    for b in range(B):
        parent = torch.zeros(T, dtype=torch.int64)
        for i in range(1, T):
            parent[i] = int(torch.randint(0, i, (1,)).item())
        for i in range(T):
            j = i
            tree_mask[b, i, j] = 1.0
            while j > 0:
                j = parent[j]
                tree_mask[b, i, j] = 1.0
    return {'q': _w((lambda *s: torch.randn(*s, dtype=torch.bfloat16) * 0.8)(B, Hq, T, D)), 'k_cache': _w((lambda *s: torch.randn(*s, dtype=torch.bfloat16) * 0.8)(B, Hkv, C, D)), 'v_cache': _w((lambda *s: torch.randn(*s, dtype=torch.bfloat16) * 0.05)(B, Hkv, C, D)), 'k_tree': _w((lambda *s: torch.randn(*s, dtype=torch.bfloat16) * 0.8)(B, Hkv, T, D)), 'v_tree': _w((lambda *s: torch.randn(*s, dtype=torch.bfloat16) * 0.05)(B, Hkv, T, D)), 'tree_mask': _w(tree_mask)}

def reference(q, k_cache, v_cache, k_tree, v_tree, tree_mask):
    B, Hq, T, D = q.shape
    Hkv, C = (k_cache.shape[1], k_cache.shape[2])
    rep = Hq // Hkv
    kc = (lambda x, n, axis: torch.repeat_interleave(x, n, dim=axis))(k_cache, rep, axis=1)
    vc = (lambda x, n, axis: torch.repeat_interleave(x, n, dim=axis))(v_cache, rep, axis=1)
    kt = (lambda x, n, axis: torch.repeat_interleave(x, n, dim=axis))(k_tree, rep, axis=1)
    vt = (lambda x, n, axis: torch.repeat_interleave(x, n, dim=axis))(v_tree, rep, axis=1)
    k = torch.concatenate([kc, kt], axis=2)
    v = torch.concatenate([vc, vt], axis=2)
    scale = D ** (-0.5)
    scores = torch.einsum('bhqd,bhkd->bhqk', q, k) * scale
    ctx_mask = torch.ones((B, 1, T, C), dtype=scores.dtype)
    tm = tree_mask[:, None, :, :].clone()
    full_mask = torch.concatenate([ctx_mask, tm], axis=-1)
    scores = scores + (1.0 - full_mask) * -1000000000.0
    p = _softmax(scores, axis=-1)
    return torch.einsum('bhqk,bhkd->bhqd', p, v)
```

```asm
; @launch grid=(256,1,1) block=(320,1,1) lds=17408
.amdgcn_target "amdgcn-amd-amdhsa--gfx950"
.text
.globl standalone__tree_speculative_verify_tree_attention_over_candidate_token_tree__decode_kernel
.p2align 8
.type standalone__tree_speculative_verify_tree_attention_over_candidate_token_tree__decode_kernel,@function
standalone__tree_speculative_verify_tree_attention_over_candidate_token_tree__decode_kernel:
    s_load_dwordx16 s[4:19], s[0:1], 0
    s_load_dwordx2 s[20:21], s[0:1], 64
    s_memrealtime s[86:87]
    s_cmp_ge_u32 s2, 256
    s_cbranch_scc1 L_end
    v_readfirstlane_b32 s69, v0
    v_mov_b32 v12, 0x4380
    v_mov_b32 v24, 0
    v_mov_b32 v25, 0
    s_cmp_ge_u32 s69, 256
    s_cbranch_scc0 L_worker
    ds_write_b64 v12, v[24:25]
    ds_write_b64 v12, v[24:25] offset:8
    ds_write_b64 v12, v[24:25] offset:16
    s_waitcnt lgkmcnt(0)
    s_barrier
    s_branch L_helper
L_worker:
    s_and_b32 s22, s2, 7
    s_lshr_b32 s23, s2, 3
    v_lshrrev_b32 v10, 6, v0
    v_and_b32 v11, 63, v0
    v_lshlrev_b32 v14, 13, v10
    v_lshl_add_u32 v2, v11, 4, v14
    v_bfe_u32 v5, v0, 4, 2
    v_and_b32 v6, 3, v0
    v_lshlrev_b32 v4, 4, v6
    v_lshl_add_u32 v4, v5, 6, v4
    v_bfe_u32 v6, v0, 2, 2
    v_lshl_add_u32 v1, v6, 8, v4
    v_add_u32 v1, v14, v1
    v_and_b32 v6, 7, v0
    v_lshlrev_b32 v9, 4, v6
    v_lshlrev_b32 v6, 8, v6
    v_lshl_add_u32 v6, v5, 6, v6
    v_bfe_u32 v5, v0, 3, 1
    v_lshl_add_u32 v6, v5, 4, v6
    v_lshrrev_b32 v5, 3, v0
    v_lshl_add_u32 v9, v5, 12, v9
    v_xor_b32 v14, 0x2000, v1
    v_xor_b32 v15, 0x2000, v2
    s_lshl_b32 s3, s22, 23
    s_lshl_b32 s40, s23, 18
    s_add_u32 s3, s3, s40
    s_lshl_b32 s41, s22, 11
    s_mov_b32 s26, 0x40000
    s_mov_b32 s27, 0x20000
    s_mov_b32 s34, 0x4000
    s_mov_b32 s35, 0x20000
    s_movk_i32 s91, 0x1000
    s_waitcnt lgkmcnt(0)
    s_add_u32 s24, s6, s3
    s_addc_u32 s25, s7, 0
    buffer_load_dwordx4 v[24:27], v1, s[24:27], 0 offen offset:0 nt
    s_mov_b32 s32, s4
    s_mov_b32 s33, s5
    buffer_load_dwordx4 v[16:19], v6, s[32:35], s41 offen
    buffer_load_dwordx4 v[20:23], v6, s[32:35], s41 offen offset:32
    buffer_load_dwordx4 v[28:31], v1, s[24:27], 0 offen offset:1024 nt
    buffer_load_dwordx4 v[32:35], v1, s[24:27], 0 offen offset:2048 nt
    buffer_load_dwordx4 v[36:39], v1, s[24:27], 0 offen offset:3072 nt
    buffer_load_dwordx4 v[40:43], v1, s[24:27], s91 offen offset:0 nt
    buffer_load_dwordx4 v[44:47], v1, s[24:27], s91 offen offset:1024 nt
    buffer_load_dwordx4 v[48:51], v1, s[24:27], s91 offen offset:2048 nt
    buffer_load_dwordx4 v[52:55], v1, s[24:27], s91 offen offset:3072 nt
    s_mov_b32 s36, s20
    s_mov_b32 s37, s21
    s_mov_b32 s38, 0x208000
    s_mov_b32 s39, 0x20000
    s_lshl_b32 s92, s22, 17
    s_lshl_b32 s95, s23, 7
    s_add_u32 s92, s92, s95
    s_cmp_eq_u32 s69, 64
    s_cbranch_scc0 L_side_done
    s_mov_b32 s48, s10
    s_and_b32 s49, s11, 0xffff
    s_mov_b32 s50, 0x800
    s_mov_b32 s51, 0x20000
    s_lshl_b32 s61, s22, 8
    buffer_load_dwordx4 v[252:255], v4, s[48:51], s61 offen
L_side_done:
    s_add_u32 s28, s8, s3
    s_addc_u32 s29, s9, 0
    s_mov_b32 s30, 0x40000
    s_mov_b32 s31, 0x20000
    s_mov_b32 s101, 0xfffffffe
    s_mov_b32 s68, 0x3e0293ee
    s_mov_b32 s42, 0x05040100
    s_mov_b32 s43, 0x07060302
    v_mov_b32 v13, 1
    v_and_b32 v8, 15, v0
    v_lshlrev_b32 v8, 4, v8
    v_lshl_add_u32 v8, v10, 2, v8
    v_lshrrev_b32 v7, 5, v0
    v_lshlrev_b32 v7, 4, v7
    v_and_b32 v3, 7, v0
    v_mul_u32_u24 v3, 528, v3
    v_lshl_add_u32 v3, v10, 12, v3
    v_bfe_u32 v5, v0, 4, 2
    v_lshl_add_u32 v3, v5, 7, v3
    v_and_b32 v5, 8, v0
    v_lshlrev_b32 v5, 3, v5
    v_xor_b32 v3, v5, v3
    s_barrier
    s_waitcnt vmcnt(6)
    s_mov_b32 s90, 0x8000
    buffer_load_dwordx4 v[56:59], v14, s[24:27], s90 offen offset:0 nt
    v_mfma_f32_16x16x32_bf16 v[218:221], v[24:27], v[16:19], 0
    v_mfma_f32_16x16x32_bf16 v[222:225], v[28:31], v[16:19], 0
    s_waitcnt vmcnt(6)
    buffer_load_dwordx4 v[60:63], v14, s[24:27], s90 offen offset:1024 nt
    v_mfma_f32_16x16x32_bf16 v[226:229], v[32:35], v[16:19], 0
    s_nop 1
    v_mfma_f32_16x16x32_bf16 v[216:219], v[24:27], v[20:23], v[216:219]
    s_waitcnt vmcnt(6)
    buffer_load_dwordx4 v[64:67], v14, s[24:27], s90 offen offset:2048 nt
    v_mfma_f32_16x16x32_bf16 v[230:233], v[36:39], v[16:19], 0
    v_mfma_f32_16x16x32_bf16 v[220:223], v[28:31], v[20:23], v[220:223]
    s_waitcnt vmcnt(6)
    buffer_load_dwordx4 v[68:71], v14, s[24:27], s90 offen offset:3072 nt
    v_mfma_f32_16x16x32_bf16 v[234:237], v[40:43], v[16:19], 0
    v_mfma_f32_16x16x32_bf16 v[224:227], v[32:35], v[20:23], v[224:227]
    s_waitcnt vmcnt(6)
    s_mov_b32 s90, 0x9000
    buffer_load_dwordx4 v[72:75], v14, s[24:27], s90 offen offset:0 nt
    v_mfma_f32_16x16x32_bf16 v[238:241], v[44:47], v[16:19], 0
    v_mfma_f32_16x16x32_bf16 v[228:231], v[36:39], v[20:23], v[228:231]
    v_add_f32_dpp v152, v219, v218 row_ror:8 row_mask:0xf bank_mask:0xf
    s_waitcnt vmcnt(6)
    buffer_load_dwordx4 v[76:79], v14, s[24:27], s90 offen offset:1024 nt
    v_mfma_f32_16x16x32_bf16 v[242:245], v[48:51], v[16:19], 0
    v_mfma_f32_16x16x32_bf16 v[232:235], v[40:43], v[20:23], v[232:235]
    v_add_f32_dpp v153, v223, v222 row_ror:8 row_mask:0xf bank_mask:0xf
    v_max_f32 v4, v152, v153
    s_waitcnt vmcnt(6)
    buffer_load_dwordx4 v[80:83], v14, s[24:27], s90 offen offset:2048 nt
    v_mfma_f32_16x16x32_bf16 v[246:249], v[52:55], v[16:19], 0
    v_mfma_f32_16x16x32_bf16 v[236:239], v[44:47], v[20:23], v[236:239]
    v_add_f32_dpp v154, v227, v226 row_ror:8 row_mask:0xf bank_mask:0xf
    s_waitcnt vmcnt(6)
    buffer_load_dwordx4 v[84:87], v14, s[24:27], s90 offen offset:3072 nt
    v_mfma_f32_16x16x32_bf16 v[218:221], v[56:59], v[16:19], 0
    v_mfma_f32_16x16x32_bf16 v[240:243], v[48:51], v[20:23], v[240:243]
    v_add_f32_dpp v155, v231, v230 row_ror:8 row_mask:0xf bank_mask:0xf
    v_max3_f32 v4, v154, v155, v4
    s_waitcnt vmcnt(5)
    s_mov_b32 s90, 0x10000
    buffer_load_dwordx4 v[88:91], v1, s[24:27], s90 offen offset:0 nt
    v_mfma_f32_16x16x32_bf16 v[222:225], v[60:63], v[16:19], 0
    v_mfma_f32_16x16x32_bf16 v[244:247], v[52:55], v[20:23], v[244:247]
    v_add_f32_dpp v156, v235, v234 row_ror:8 row_mask:0xf bank_mask:0xf
    v_mfma_f32_16x16x32_bf16 v[226:229], v[64:67], v[16:19], 0
    v_mfma_f32_16x16x32_bf16 v[216:219], v[56:59], v[20:23], v[216:219]
    v_add_f32_dpp v157, v239, v238 row_ror:8 row_mask:0xf bank_mask:0xf
    v_max3_f32 v4, v156, v157, v4
    s_cmp_eq_u32 s69, 64
    s_cbranch_scc0 L_notree
    v_mfma_f32_16x16x32_bf16 v[186:189], v[252:255], v[16:19], 0
    s_nop 5
    v_mfma_f32_16x16x32_bf16 v[184:187], v[252:255], v[20:23], v[184:187]
    v_and_b32 v5, 15, v0
    v_lshlrev_b32 v5, 2, v5
    s_nop 5
    v_add_f32_dpp v6, v187, v186 row_ror:8 row_mask:0xf bank_mask:0xf
    ds_write_b32 v5, v6 offset:17152
L_notree:
    s_waitcnt vmcnt(5)
    buffer_load_dwordx4 v[92:95], v1, s[24:27], s90 offen offset:1024 nt
    v_mfma_f32_16x16x32_bf16 v[230:233], v[68:71], v[16:19], 0
    v_mfma_f32_16x16x32_bf16 v[220:223], v[60:63], v[20:23], v[220:223]
    v_add_f32_dpp v158, v243, v242 row_ror:8 row_mask:0xf bank_mask:0xf
    s_waitcnt vmcnt(5)
    buffer_load_dwordx4 v[96:99], v1, s[24:27], s90 offen offset:2048 nt
    v_mfma_f32_16x16x32_bf16 v[234:237], v[72:75], v[16:19], 0
    v_mfma_f32_16x16x32_bf16 v[224:227], v[64:67], v[20:23], v[224:227]
    v_add_f32_dpp v159, v247, v246 row_ror:8 row_mask:0xf bank_mask:0xf
    v_max3_f32 v4, v158, v159, v4
    s_waitcnt vmcnt(5)
    buffer_load_dwordx4 v[100:103], v1, s[24:27], s90 offen offset:3072 nt
    v_mfma_f32_16x16x32_bf16 v[238:241], v[76:79], v[16:19], 0
    v_mfma_f32_16x16x32_bf16 v[228:231], v[68:71], v[20:23], v[228:231]
    v_add_f32_dpp v160, v219, v218 row_ror:8 row_mask:0xf bank_mask:0xf
    s_waitcnt vmcnt(5)
    s_mov_b32 s90, 0x11000
    buffer_load_dwordx4 v[104:107], v1, s[24:27], s90 offen offset:0 nt
    v_mfma_f32_16x16x32_bf16 v[242:245], v[80:83], v[16:19], 0
    v_mfma_f32_16x16x32_bf16 v[232:235], v[72:75], v[20:23], v[232:235]
    v_add_f32_dpp v161, v223, v222 row_ror:8 row_mask:0xf bank_mask:0xf
    v_max3_f32 v4, v160, v161, v4
    s_waitcnt vmcnt(5)
    buffer_load_dwordx4 v[108:111], v1, s[24:27], s90 offen offset:1024 nt
    v_mfma_f32_16x16x32_bf16 v[246:249], v[84:87], v[16:19], 0
    v_mfma_f32_16x16x32_bf16 v[236:239], v[76:79], v[20:23], v[236:239]
    v_add_f32_dpp v162, v227, v226 row_ror:8 row_mask:0xf bank_mask:0xf
    s_waitcnt vmcnt(5)
    buffer_load_dwordx4 v[112:115], v1, s[24:27], s90 offen offset:2048 nt
    v_mfma_f32_16x16x32_bf16 v[218:221], v[88:91], v[16:19], 0
    v_mfma_f32_16x16x32_bf16 v[240:243], v[80:83], v[20:23], v[240:243]
    v_add_f32_dpp v163, v231, v230 row_ror:8 row_mask:0xf bank_mask:0xf
    v_max3_f32 v4, v162, v163, v4
    s_waitcnt vmcnt(5)
    buffer_load_dwordx4 v[116:119], v1, s[24:27], s90 offen offset:3072 nt
    s_memrealtime s[62:63]
    ds_read_b32 v252, v12 offset:16
    v_mfma_f32_16x16x32_bf16 v[222:225], v[92:95], v[16:19], 0
    v_mfma_f32_16x16x32_bf16 v[244:247], v[84:87], v[20:23], v[244:247]
    v_add_f32_dpp v164, v235, v234 row_ror:8 row_mask:0xf bank_mask:0xf
    s_waitcnt lgkmcnt(0)
    v_readfirstlane_b32 s60, v252
    s_nop 1
    s_sub_u32 s61, s62, s60
    s_cmp_lg_u32 s60, 0
    s_cselect_b32 s61, s61, 0
    s_cmp_gt_u32 s61, 374
    s_cselect_b64 vcc, -1, 0
    s_cbranch_vccnz L_th24
    s_waitcnt vmcnt(4)
L_th24:
    s_waitcnt vmcnt(7)
    s_mov_b32 s90, 0x18000
    buffer_load_dwordx4 v[120:123], v14, s[24:27], s90 offen offset:0 nt
    s_cbranch_vccnz L_th25
    s_waitcnt vmcnt(4)
L_th25:
    s_waitcnt vmcnt(7)
    buffer_load_dwordx4 v[124:127], v14, s[24:27], s90 offen offset:1024 nt
    s_cbranch_vccnz L_th26
    s_waitcnt vmcnt(4)
L_th26:
    s_waitcnt vmcnt(7)
    buffer_load_dwordx4 v[128:131], v14, s[24:27], s90 offen offset:2048 nt
    v_mfma_f32_16x16x32_bf16 v[226:229], v[96:99], v[16:19], 0
    v_mfma_f32_16x16x32_bf16 v[216:219], v[88:91], v[20:23], v[216:219]
    v_add_f32_dpp v165, v239, v238 row_ror:8 row_mask:0xf bank_mask:0xf
    v_max3_f32 v4, v164, v165, v4
    s_cbranch_vccnz L_th27
    s_waitcnt vmcnt(4)
L_th27:
    s_waitcnt vmcnt(7)
    buffer_load_dwordx4 v[132:135], v14, s[24:27], s90 offen offset:3072 nt
    s_memrealtime s[62:63]
    ds_read_b32 v252, v12 offset:16
    v_mfma_f32_16x16x32_bf16 v[230:233], v[100:103], v[16:19], 0
    v_mfma_f32_16x16x32_bf16 v[220:223], v[92:95], v[20:23], v[220:223]
    v_add_f32_dpp v166, v243, v242 row_ror:8 row_mask:0xf bank_mask:0xf
    s_waitcnt lgkmcnt(0)
    v_readfirstlane_b32 s60, v252
    s_nop 1
    s_sub_u32 s61, s62, s60
    s_cmp_lg_u32 s60, 0
    s_cselect_b32 s61, s61, 0
    s_cmp_gt_u32 s61, 429
    s_cselect_b64 vcc, -1, 0
    s_cbranch_vccnz L_th28
    s_waitcnt vmcnt(4)
L_th28:
    s_waitcnt vmcnt(7)
    s_mov_b32 s90, 0x19000
    buffer_load_dwordx4 v[136:139], v14, s[24:27], s90 offen offset:0 nt
    v_mfma_f32_16x16x32_bf16 v[234:237], v[104:107], v[16:19], 0
    v_mfma_f32_16x16x32_bf16 v[224:227], v[96:99], v[20:23], v[224:227]
    v_add_f32_dpp v167, v247, v246 row_ror:8 row_mask:0xf bank_mask:0xf
    v_max3_f32 v4, v166, v167, v4
    s_cbranch_vccnz L_th29
    s_waitcnt vmcnt(4)
L_th29:
    s_waitcnt vmcnt(7)
    buffer_load_dwordx4 v[140:143], v14, s[24:27], s90 offen offset:1024 nt
    v_mfma_f32_16x16x32_bf16 v[238:241], v[108:111], v[16:19], 0
    v_mfma_f32_16x16x32_bf16 v[228:231], v[100:103], v[20:23], v[228:231]
    v_add_f32_dpp v168, v219, v218 row_ror:8 row_mask:0xf bank_mask:0xf
    s_cbranch_vccnz L_th30
    s_waitcnt vmcnt(4)
L_th30:
    s_waitcnt vmcnt(7)
    buffer_load_dwordx4 v[144:147], v14, s[24:27], s90 offen offset:2048 nt
    v_mfma_f32_16x16x32_bf16 v[242:245], v[112:115], v[16:19], 0
    v_mfma_f32_16x16x32_bf16 v[232:235], v[104:107], v[20:23], v[232:235]
    v_add_f32_dpp v169, v223, v222 row_ror:8 row_mask:0xf bank_mask:0xf
    v_max3_f32 v4, v168, v169, v4
    s_cbranch_vccnz L_th31
    s_waitcnt vmcnt(4)
L_th31:
    s_waitcnt vmcnt(7)
    buffer_load_dwordx4 v[148:151], v14, s[24:27], s90 offen offset:3072 nt
    s_memrealtime s[62:63]
    ds_read_b32 v252, v12 offset:16
    v_mfma_f32_16x16x32_bf16 v[246:249], v[116:119], v[16:19], 0
    v_mfma_f32_16x16x32_bf16 v[236:239], v[108:111], v[20:23], v[236:239]
    v_add_f32_dpp v170, v227, v226 row_ror:8 row_mask:0xf bank_mask:0xf
    s_waitcnt lgkmcnt(0)
    v_readfirstlane_b32 s60, v252
    s_nop 1
    s_sub_u32 s61, s62, s60
    s_cmp_lg_u32 s60, 0
    s_cselect_b32 s61, s61, 0
    s_cmp_gt_u32 s61, 483
    s_cselect_b64 vcc, -1, 0
    s_cbranch_vccnz L_th32
    s_waitcnt vmcnt(4)
L_th32:
    s_waitcnt vmcnt(7)
    s_mov_b32 s90, 0x20000
    buffer_load_dwordx4 v[24:27], v1, s[24:27], s90 offen offset:0 nt
    v_mfma_f32_16x16x32_bf16 v[218:221], v[120:123], v[16:19], 0
    v_mfma_f32_16x16x32_bf16 v[240:243], v[112:115], v[20:23], v[240:243]
    v_add_f32_dpp v171, v231, v230 row_ror:8 row_mask:0xf bank_mask:0xf
    v_max3_f32 v4, v170, v171, v4
    s_cbranch_vccnz L_th33
    s_waitcnt vmcnt(4)
L_th33:
    s_waitcnt vmcnt(7)
    buffer_load_dwordx4 v[28:31], v1, s[24:27], s90 offen offset:1024 nt
    v_mfma_f32_16x16x32_bf16 v[222:225], v[124:127], v[16:19], 0
    v_mfma_f32_16x16x32_bf16 v[244:247], v[116:119], v[20:23], v[244:247]
    v_add_f32_dpp v172, v235, v234 row_ror:8 row_mask:0xf bank_mask:0xf
    s_cbranch_vccnz L_th34
    s_waitcnt vmcnt(4)
L_th34:
    s_waitcnt vmcnt(7)
    buffer_load_dwordx4 v[32:35], v1, s[24:27], s90 offen offset:2048 nt
    v_mfma_f32_16x16x32_bf16 v[226:229], v[128:131], v[16:19], 0
    v_mfma_f32_16x16x32_bf16 v[216:219], v[120:123], v[20:23], v[216:219]
    v_add_f32_dpp v173, v239, v238 row_ror:8 row_mask:0xf bank_mask:0xf
    v_max3_f32 v4, v172, v173, v4
    s_cbranch_vccnz L_th35
    s_waitcnt vmcnt(4)
L_th35:
    s_waitcnt vmcnt(7)
    buffer_load_dwordx4 v[36:39], v1, s[24:27], s90 offen offset:3072 nt
    s_memrealtime s[62:63]
    ds_read_b32 v252, v12 offset:16
    v_mfma_f32_16x16x32_bf16 v[230:233], v[132:135], v[16:19], 0
    v_mfma_f32_16x16x32_bf16 v[220:223], v[124:127], v[20:23], v[220:223]
    v_add_f32_dpp v174, v243, v242 row_ror:8 row_mask:0xf bank_mask:0xf
    s_waitcnt lgkmcnt(0)
    v_readfirstlane_b32 s60, v252
    s_nop 1
    s_sub_u32 s61, s62, s60
    s_cmp_lg_u32 s60, 0
    s_cselect_b32 s61, s61, 0
    s_cmp_gt_u32 s61, 538
    s_cselect_b64 vcc, -1, 0
    s_cbranch_vccnz L_th36
    s_waitcnt vmcnt(4)
L_th36:
    s_waitcnt vmcnt(7)
    s_mov_b32 s90, 0x21000
    buffer_load_dwordx4 v[40:43], v1, s[24:27], s90 offen offset:0 nt
    v_mfma_f32_16x16x32_bf16 v[234:237], v[136:139], v[16:19], 0
    v_mfma_f32_16x16x32_bf16 v[224:227], v[128:131], v[20:23], v[224:227]
    v_add_f32_dpp v175, v247, v246 row_ror:8 row_mask:0xf bank_mask:0xf
    v_max3_f32 v4, v174, v175, v4
    s_cbranch_vccnz L_th37
    s_waitcnt vmcnt(4)
L_th37:
    s_waitcnt vmcnt(7)
    buffer_load_dwordx4 v[44:47], v1, s[24:27], s90 offen offset:1024 nt
    v_mfma_f32_16x16x32_bf16 v[238:241], v[140:143], v[16:19], 0
    v_mfma_f32_16x16x32_bf16 v[228:231], v[132:135], v[20:23], v[228:231]
    v_add_f32_dpp v176, v219, v218 row_ror:8 row_mask:0xf bank_mask:0xf
    s_cbranch_vccnz L_th38
    s_waitcnt vmcnt(4)
L_th38:
    s_waitcnt vmcnt(7)
    buffer_load_dwordx4 v[48:51], v1, s[24:27], s90 offen offset:2048 nt
    v_mfma_f32_16x16x32_bf16 v[242:245], v[144:147], v[16:19], 0
    v_mfma_f32_16x16x32_bf16 v[232:235], v[136:139], v[20:23], v[232:235]
    v_add_f32_dpp v177, v223, v222 row_ror:8 row_mask:0xf bank_mask:0xf
    v_max3_f32 v4, v176, v177, v4
    s_cbranch_vccnz L_th39
    s_waitcnt vmcnt(4)
L_th39:
    s_waitcnt vmcnt(7)
    buffer_load_dwordx4 v[52:55], v1, s[24:27], s90 offen offset:3072 nt
    s_memrealtime s[62:63]
    ds_read_b32 v252, v12 offset:16
    v_mfma_f32_16x16x32_bf16 v[246:249], v[148:151], v[16:19], 0
    v_mfma_f32_16x16x32_bf16 v[236:239], v[140:143], v[20:23], v[236:239]
    v_add_f32_dpp v178, v227, v226 row_ror:8 row_mask:0xf bank_mask:0xf
    s_waitcnt lgkmcnt(0)
    v_readfirstlane_b32 s60, v252
    s_nop 1
    s_sub_u32 s61, s62, s60
    s_cmp_lg_u32 s60, 0
    s_cselect_b32 s61, s61, 0
    s_cmp_gt_u32 s61, 593
    s_cselect_b64 vcc, -1, 0
    s_cbranch_vccnz L_th40
    s_waitcnt vmcnt(4)
L_th40:
    s_waitcnt vmcnt(7)
    s_mov_b32 s90, 0x28000
    buffer_load_dwordx4 v[56:59], v14, s[24:27], s90 offen offset:0 nt
    v_mfma_f32_16x16x32_bf16 v[218:221], v[24:27], v[16:19], 0
    v_mfma_f32_16x16x32_bf16 v[240:243], v[144:147], v[20:23], v[240:243]
    v_add_f32_dpp v179, v231, v230 row_ror:8 row_mask:0xf bank_mask:0xf
    v_max3_f32 v4, v178, v179, v4
    s_cbranch_vccnz L_th41
    s_waitcnt vmcnt(4)
L_th41:
    s_waitcnt vmcnt(7)
    buffer_load_dwordx4 v[60:63], v14, s[24:27], s90 offen offset:1024 nt
    v_mfma_f32_16x16x32_bf16 v[222:225], v[28:31], v[16:19], 0
    v_mfma_f32_16x16x32_bf16 v[244:247], v[148:151], v[20:23], v[244:247]
    v_add_f32_dpp v180, v235, v234 row_ror:8 row_mask:0xf bank_mask:0xf
    s_cbranch_vccnz L_th42
    s_waitcnt vmcnt(4)
L_th42:
    s_waitcnt vmcnt(7)
    buffer_load_dwordx4 v[64:67], v14, s[24:27], s90 offen offset:2048 nt
    v_mfma_f32_16x16x32_bf16 v[226:229], v[32:35], v[16:19], 0
    v_mfma_f32_16x16x32_bf16 v[216:219], v[24:27], v[20:23], v[216:219]
    v_add_f32_dpp v181, v239, v238 row_ror:8 row_mask:0xf bank_mask:0xf
    v_max3_f32 v4, v180, v181, v4
    s_cbranch_vccnz L_th43
    s_waitcnt vmcnt(4)
L_th43:
    s_waitcnt vmcnt(7)
    buffer_load_dwordx4 v[68:71], v14, s[24:27], s90 offen offset:3072 nt
    s_memrealtime s[62:63]
    ds_read_b32 v252, v12 offset:16
    v_mfma_f32_16x16x32_bf16 v[230:233], v[36:39], v[16:19], 0
    v_mfma_f32_16x16x32_bf16 v[220:223], v[28:31], v[20:23], v[220:223]
    v_add_f32_dpp v182, v243, v242 row_ror:8 row_mask:0xf bank_mask:0xf
    s_waitcnt lgkmcnt(0)
    v_readfirstlane_b32 s60, v252
    s_nop 1
    s_sub_u32 s61, s62, s60
    s_cmp_lg_u32 s60, 0
    s_cselect_b32 s61, s61, 0
    s_cmp_gt_u32 s61, 648
    s_cselect_b64 vcc, -1, 0
    s_cbranch_vccnz L_th44
    s_waitcnt vmcnt(4)
L_th44:
    s_waitcnt vmcnt(7)
    s_mov_b32 s90, 0x29000
    buffer_load_dwordx4 v[72:75], v14, s[24:27], s90 offen offset:0 nt
    v_mfma_f32_16x16x32_bf16 v[234:237], v[40:43], v[16:19], 0
    v_mfma_f32_16x16x32_bf16 v[224:227], v[32:35], v[20:23], v[224:227]
    v_add_f32_dpp v183, v247, v246 row_ror:8 row_mask:0xf bank_mask:0xf
    v_max3_f32 v4, v182, v183, v4
    s_cbranch_vccnz L_th45
    s_waitcnt vmcnt(4)
L_th45:
    s_waitcnt vmcnt(7)
    buffer_load_dwordx4 v[76:79], v14, s[24:27], s90 offen offset:1024 nt
    v_mfma_f32_16x16x32_bf16 v[238:241], v[44:47], v[16:19], 0
    v_mfma_f32_16x16x32_bf16 v[228:231], v[36:39], v[20:23], v[228:231]
    v_add_f32_dpp v184, v219, v218 row_ror:8 row_mask:0xf bank_mask:0xf
    s_cbranch_vccnz L_th46
    s_waitcnt vmcnt(4)
L_th46:
    s_waitcnt vmcnt(7)
    buffer_load_dwordx4 v[80:83], v14, s[24:27], s90 offen offset:2048 nt
    v_mfma_f32_16x16x32_bf16 v[242:245], v[48:51], v[16:19], 0
    v_mfma_f32_16x16x32_bf16 v[232:235], v[40:43], v[20:23], v[232:235]
    v_add_f32_dpp v185, v223, v222 row_ror:8 row_mask:0xf bank_mask:0xf
    v_max3_f32 v4, v184, v185, v4
    s_cbranch_vccnz L_th47
    s_waitcnt vmcnt(4)
L_th47:
    s_waitcnt vmcnt(7)
    buffer_load_dwordx4 v[84:87], v14, s[24:27], s90 offen offset:3072 nt
    s_memrealtime s[62:63]
    ds_read_b32 v252, v12 offset:16
    v_mfma_f32_16x16x32_bf16 v[246:249], v[52:55], v[16:19], 0
    v_mfma_f32_16x16x32_bf16 v[236:239], v[44:47], v[20:23], v[236:239]
    v_add_f32_dpp v186, v227, v226 row_ror:8 row_mask:0xf bank_mask:0xf
    s_waitcnt lgkmcnt(0)
    v_readfirstlane_b32 s60, v252
    s_nop 1
    s_sub_u32 s61, s62, s60
    s_cmp_lg_u32 s60, 0
    s_cselect_b32 s61, s61, 0
    s_cmp_gt_u32 s61, 703
    s_cselect_b64 vcc, -1, 0
    s_cbranch_vccnz L_th48
    s_waitcnt vmcnt(4)
L_th48:
    s_waitcnt vmcnt(7)
    s_mov_b32 s90, 0x30000
    buffer_load_dwordx4 v[88:91], v1, s[24:27], s90 offen offset:0 nt
    v_mfma_f32_16x16x32_bf16 v[218:221], v[56:59], v[16:19], 0
    v_mfma_f32_16x16x32_bf16 v[240:243], v[48:51], v[20:23], v[240:243]
    v_add_f32_dpp v187, v231, v230 row_ror:8 row_mask:0xf bank_mask:0xf
    v_max3_f32 v4, v186, v187, v4
    s_cbranch_vccnz L_th49
    s_waitcnt vmcnt(4)
L_th49:
    s_waitcnt vmcnt(7)
    buffer_load_dwordx4 v[92:95], v1, s[24:27], s90 offen offset:1024 nt
    v_mfma_f32_16x16x32_bf16 v[222:225], v[60:63], v[16:19], 0
    v_mfma_f32_16x16x32_bf16 v[244:247], v[52:55], v[20:23], v[244:247]
    v_add_f32_dpp v188, v235, v234 row_ror:8 row_mask:0xf bank_mask:0xf
    s_cbranch_vccnz L_th50
    s_waitcnt vmcnt(4)
L_th50:
    s_waitcnt vmcnt(7)
    buffer_load_dwordx4 v[96:99], v1, s[24:27], s90 offen offset:2048 nt
    v_mfma_f32_16x16x32_bf16 v[226:229], v[64:67], v[16:19], 0
    v_mfma_f32_16x16x32_bf16 v[216:219], v[56:59], v[20:23], v[216:219]
    v_add_f32_dpp v189, v239, v238 row_ror:8 row_mask:0xf bank_mask:0xf
    v_max3_f32 v4, v188, v189, v4
    s_cbranch_vccnz L_th51
    s_waitcnt vmcnt(4)
L_th51:
    s_waitcnt vmcnt(7)
    buffer_load_dwordx4 v[100:103], v1, s[24:27], s90 offen offset:3072 nt
    s_memrealtime s[62:63]
    ds_read_b32 v252, v12 offset:16
    v_mfma_f32_16x16x32_bf16 v[230:233], v[68:71], v[16:19], 0
    v_mfma_f32_16x16x32_bf16 v[220:223], v[60:63], v[20:23], v[220:223]
    v_add_f32_dpp v190, v243, v242 row_ror:8 row_mask:0xf bank_mask:0xf
    s_waitcnt lgkmcnt(0)
    v_readfirstlane_b32 s60, v252
    s_nop 1
    s_sub_u32 s61, s62, s60
    s_cmp_lg_u32 s60, 0
    s_cselect_b32 s61, s61, 0
    s_cmp_gt_u32 s61, 757
    s_cselect_b64 vcc, -1, 0
    s_cbranch_vccnz L_th52
    s_waitcnt vmcnt(4)
L_th52:
    s_waitcnt vmcnt(7)
    s_mov_b32 s90, 0x31000
    buffer_load_dwordx4 v[104:107], v1, s[24:27], s90 offen offset:0 nt
    v_mfma_f32_16x16x32_bf16 v[234:237], v[72:75], v[16:19], 0
    v_mfma_f32_16x16x32_bf16 v[224:227], v[64:67], v[20:23], v[224:227]
    v_add_f32_dpp v191, v247, v246 row_ror:8 row_mask:0xf bank_mask:0xf
    v_max3_f32 v4, v190, v191, v4
    s_cbranch_vccnz L_th53
    s_waitcnt vmcnt(4)
L_th53:
    s_waitcnt vmcnt(7)
    buffer_load_dwordx4 v[108:111], v1, s[24:27], s90 offen offset:1024 nt
    v_mfma_f32_16x16x32_bf16 v[238:241], v[76:79], v[16:19], 0
    v_mfma_f32_16x16x32_bf16 v[228:231], v[68:71], v[20:23], v[228:231]
    v_add_f32_dpp v192, v219, v218 row_ror:8 row_mask:0xf bank_mask:0xf
    s_cbranch_vccnz L_th54
    s_waitcnt vmcnt(4)
L_th54:
    s_waitcnt vmcnt(7)
    buffer_load_dwordx4 v[112:115], v1, s[24:27], s90 offen offset:2048 nt
    v_mfma_f32_16x16x32_bf16 v[242:245], v[80:83], v[16:19], 0
    v_mfma_f32_16x16x32_bf16 v[232:235], v[72:75], v[20:23], v[232:235]
    v_add_f32_dpp v193, v223, v222 row_ror:8 row_mask:0xf bank_mask:0xf
    v_max3_f32 v4, v192, v193, v4
    s_cbranch_vccnz L_th55
    s_waitcnt vmcnt(4)
L_th55:
    s_waitcnt vmcnt(7)
    buffer_load_dwordx4 v[116:119], v1, s[24:27], s90 offen offset:3072 nt
    s_memrealtime s[62:63]
    ds_read_b32 v252, v12 offset:16
    v_mfma_f32_16x16x32_bf16 v[246:249], v[84:87], v[16:19], 0
    v_mfma_f32_16x16x32_bf16 v[236:239], v[76:79], v[20:23], v[236:239]
    v_add_f32_dpp v194, v227, v226 row_ror:8 row_mask:0xf bank_mask:0xf
    s_waitcnt lgkmcnt(0)
    v_readfirstlane_b32 s60, v252
    s_nop 1
    s_sub_u32 s61, s62, s60
    s_cmp_lg_u32 s60, 0
    s_cselect_b32 s61, s61, 0
    s_cmp_gt_u32 s61, 812
    s_cselect_b64 vcc, -1, 0
    s_cbranch_vccnz L_th56
    s_waitcnt vmcnt(4)
L_th56:
    s_waitcnt vmcnt(7)
    s_mov_b32 s90, 0x38000
    buffer_load_dwordx4 v[120:123], v14, s[24:27], s90 offen offset:0 nt
    v_mfma_f32_16x16x32_bf16 v[218:221], v[88:91], v[16:19], 0
    v_mfma_f32_16x16x32_bf16 v[240:243], v[80:83], v[20:23], v[240:243]
    v_add_f32_dpp v195, v231, v230 row_ror:8 row_mask:0xf bank_mask:0xf
    v_max3_f32 v4, v194, v195, v4
    s_cbranch_vccnz L_th57
    s_waitcnt vmcnt(4)
L_th57:
    s_waitcnt vmcnt(7)
    buffer_load_dwordx4 v[124:127], v14, s[24:27], s90 offen offset:1024 nt
    v_mov_b32 v252, -1
    v_mov_b32 v253, -1
    v_mov_b32 v254, -1
    v_mov_b32 v255, -1
    buffer_store_dwordx4 v[252:255], v9, s[36:39], s92 offen
    v_mfma_f32_16x16x32_bf16 v[222:225], v[92:95], v[16:19], 0
    v_mfma_f32_16x16x32_bf16 v[244:247], v[84:87], v[20:23], v[244:247]
    v_add_f32_dpp v196, v235, v234 row_ror:8 row_mask:0xf bank_mask:0xf
    s_cbranch_vccnz L_th58
    s_waitcnt vmcnt(4)
L_th58:
    s_waitcnt vmcnt(7)
    buffer_load_dwordx4 v[128:131], v14, s[24:27], s90 offen offset:2048 nt
    v_mfma_f32_16x16x32_bf16 v[226:229], v[96:99], v[16:19], 0
    v_mfma_f32_16x16x32_bf16 v[216:219], v[88:91], v[20:23], v[216:219]
    v_add_f32_dpp v197, v239, v238 row_ror:8 row_mask:0xf bank_mask:0xf
    v_max3_f32 v4, v196, v197, v4
    s_cbranch_vccnz L_th59
    s_waitcnt vmcnt(4)
L_th59:
    s_waitcnt vmcnt(7)
    buffer_load_dwordx4 v[132:135], v14, s[24:27], s90 offen offset:3072 nt
    s_memrealtime s[62:63]
    ds_read_b32 v252, v12 offset:16
    v_mfma_f32_16x16x32_bf16 v[230:233], v[100:103], v[16:19], 0
    v_mfma_f32_16x16x32_bf16 v[220:223], v[92:95], v[20:23], v[220:223]
    v_add_f32_dpp v198, v243, v242 row_ror:8 row_mask:0xf bank_mask:0xf
    s_waitcnt lgkmcnt(0)
    v_readfirstlane_b32 s60, v252
    s_nop 1
    s_sub_u32 s61, s62, s60
    s_cmp_lg_u32 s60, 0
    s_cselect_b32 s61, s61, 0
    s_cmp_gt_u32 s61, 867
    s_cselect_b64 vcc, -1, 0
    s_cbranch_vccnz L_th60
    s_waitcnt vmcnt(4)
L_th60:
    s_waitcnt vmcnt(7)
    s_mov_b32 s90, 0x39000
    buffer_load_dwordx4 v[136:139], v14, s[24:27], s90 offen offset:0 nt
    v_mfma_f32_16x16x32_bf16 v[234:237], v[104:107], v[16:19], 0
    v_mfma_f32_16x16x32_bf16 v[224:227], v[96:99], v[20:23], v[224:227]
    v_add_f32_dpp v199, v247, v246 row_ror:8 row_mask:0xf bank_mask:0xf
    v_max3_f32 v4, v198, v199, v4
    s_cbranch_vccnz L_th61
    s_waitcnt vmcnt(4)
L_th61:
    s_waitcnt vmcnt(7)
    buffer_load_dwordx4 v[140:143], v14, s[24:27], s90 offen offset:1024 nt
    v_mfma_f32_16x16x32_bf16 v[238:241], v[108:111], v[16:19], 0
    v_mfma_f32_16x16x32_bf16 v[228:231], v[100:103], v[20:23], v[228:231]
    v_add_f32_dpp v200, v219, v218 row_ror:8 row_mask:0xf bank_mask:0xf
    s_cbranch_vccnz L_th62
    s_waitcnt vmcnt(4)
L_th62:
    s_waitcnt vmcnt(7)
    buffer_load_dwordx4 v[144:147], v14, s[24:27], s90 offen offset:2048 nt
    v_mfma_f32_16x16x32_bf16 v[242:245], v[112:115], v[16:19], 0
    v_mfma_f32_16x16x32_bf16 v[232:235], v[104:107], v[20:23], v[232:235]
    v_add_f32_dpp v201, v223, v222 row_ror:8 row_mask:0xf bank_mask:0xf
    v_max3_f32 v4, v200, v201, v4
    s_cbranch_vccnz L_th63
    s_waitcnt vmcnt(4)
L_th63:
    s_waitcnt vmcnt(7)
    buffer_load_dwordx4 v[148:151], v14, s[24:27], s90 offen offset:3072 nt
    s_memrealtime s[62:63]
    ds_read_b32 v252, v12 offset:16
    v_mfma_f32_16x16x32_bf16 v[246:249], v[116:119], v[16:19], 0
    v_mfma_f32_16x16x32_bf16 v[236:239], v[108:111], v[20:23], v[236:239]
    v_add_f32_dpp v202, v227, v226 row_ror:8 row_mask:0xf bank_mask:0xf
    s_waitcnt lgkmcnt(0)
    v_readfirstlane_b32 s60, v252
    s_nop 1
    s_sub_u32 s61, s62, s60
    s_cmp_lg_u32 s60, 0
    s_cselect_b32 s61, s61, 0
    s_cmp_gt_u32 s61, 922
    s_cselect_b64 vcc, -1, 0
    s_cbranch_vccnz L_th64
    s_waitcnt vmcnt(4)
L_th64:
    s_waitcnt vmcnt(7)
    buffer_load_dwordx4 v[24:27], v2, s[28:31], 0 offen offset:0 nt
    v_mfma_f32_16x16x32_bf16 v[218:221], v[120:123], v[16:19], 0
    v_mfma_f32_16x16x32_bf16 v[240:243], v[112:115], v[20:23], v[240:243]
    v_add_f32_dpp v203, v231, v230 row_ror:8 row_mask:0xf bank_mask:0xf
    v_max3_f32 v4, v202, v203, v4
    s_cbranch_vccnz L_th65
    s_waitcnt vmcnt(4)
L_th65:
    s_waitcnt vmcnt(7)
    buffer_load_dwordx4 v[28:31], v2, s[28:31], 0 offen offset:1024 nt
    v_mfma_f32_16x16x32_bf16 v[222:225], v[124:127], v[16:19], 0
    v_mfma_f32_16x16x32_bf16 v[244:247], v[116:119], v[20:23], v[244:247]
    v_add_f32_dpp v204, v235, v234 row_ror:8 row_mask:0xf bank_mask:0xf
    s_cbranch_vccnz L_th66
    s_waitcnt vmcnt(4)
L_th66:
    s_waitcnt vmcnt(7)
    buffer_load_dwordx4 v[32:35], v2, s[28:31], 0 offen offset:2048 nt
    v_mfma_f32_16x16x32_bf16 v[226:229], v[128:131], v[16:19], 0
    v_mfma_f32_16x16x32_bf16 v[216:219], v[120:123], v[20:23], v[216:219]
    v_add_f32_dpp v205, v239, v238 row_ror:8 row_mask:0xf bank_mask:0xf
    v_max3_f32 v4, v204, v205, v4
    s_cbranch_vccnz L_th67
    s_waitcnt vmcnt(4)
L_th67:
    s_waitcnt vmcnt(7)
    buffer_load_dwordx4 v[36:39], v2, s[28:31], 0 offen offset:3072 nt
    s_memrealtime s[62:63]
    ds_read_b32 v252, v12 offset:16
    v_mfma_f32_16x16x32_bf16 v[230:233], v[132:135], v[16:19], 0
    v_mfma_f32_16x16x32_bf16 v[220:223], v[124:127], v[20:23], v[220:223]
    v_add_f32_dpp v206, v243, v242 row_ror:8 row_mask:0xf bank_mask:0xf
    s_waitcnt lgkmcnt(0)
    v_readfirstlane_b32 s60, v252
    s_nop 1
    s_sub_u32 s61, s62, s60
    s_cmp_lg_u32 s60, 0
    s_cselect_b32 s61, s61, 0
    s_cmp_gt_u32 s61, 977
    s_cselect_b64 vcc, -1, 0
    s_cbranch_vccnz L_th68
    s_waitcnt vmcnt(4)
L_th68:
    s_waitcnt vmcnt(7)
    buffer_load_dwordx4 v[40:43], v2, s[28:31], s91 offen offset:0 nt
    v_mfma_f32_16x16x32_bf16 v[234:237], v[136:139], v[16:19], 0
    v_mfma_f32_16x16x32_bf16 v[224:227], v[128:131], v[20:23], v[224:227]
    v_add_f32_dpp v207, v247, v246 row_ror:8 row_mask:0xf bank_mask:0xf
    v_max3_f32 v4, v206, v207, v4
    s_cbranch_vccnz L_th69
    s_waitcnt vmcnt(4)
L_th69:
    s_waitcnt vmcnt(7)
    buffer_load_dwordx4 v[44:47], v2, s[28:31], s91 offen offset:1024 nt
    v_mfma_f32_16x16x32_bf16 v[238:241], v[140:143], v[16:19], 0
    v_mfma_f32_16x16x32_bf16 v[228:231], v[132:135], v[20:23], v[228:231]
    v_add_f32_dpp v208, v219, v218 row_ror:8 row_mask:0xf bank_mask:0xf
    s_cbranch_vccnz L_th70
    s_waitcnt vmcnt(4)
L_th70:
    s_waitcnt vmcnt(7)
    buffer_load_dwordx4 v[48:51], v2, s[28:31], s91 offen offset:2048 nt
    v_mfma_f32_16x16x32_bf16 v[242:245], v[144:147], v[16:19], 0
    v_mfma_f32_16x16x32_bf16 v[232:235], v[136:139], v[20:23], v[232:235]
    v_add_f32_dpp v209, v223, v222 row_ror:8 row_mask:0xf bank_mask:0xf
    v_max3_f32 v4, v208, v209, v4
    s_cbranch_vccnz L_th71
    s_waitcnt vmcnt(4)
L_th71:
    s_waitcnt vmcnt(7)
    buffer_load_dwordx4 v[52:55], v2, s[28:31], s91 offen offset:3072 nt
    s_memrealtime s[62:63]
    ds_read_b32 v252, v12 offset:16
    v_mfma_f32_16x16x32_bf16 v[246:249], v[148:151], v[16:19], 0
    v_mfma_f32_16x16x32_bf16 v[236:239], v[140:143], v[20:23], v[236:239]
    v_add_f32_dpp v210, v227, v226 row_ror:8 row_mask:0xf bank_mask:0xf
    v_mfma_f32_16x16x32_bf16 v[240:243], v[144:147], v[20:23], v[240:243]
    v_add_f32_dpp v211, v231, v230 row_ror:8 row_mask:0xf bank_mask:0xf
    v_max3_f32 v4, v210, v211, v4
    s_nop 0
    v_mfma_f32_16x16x32_bf16 v[244:247], v[148:151], v[20:23], v[244:247]
    v_add_f32_dpp v212, v235, v234 row_ror:8 row_mask:0xf bank_mask:0xf
    s_nop 0
    v_add_f32_dpp v213, v239, v238 row_ror:8 row_mask:0xf bank_mask:0xf
    v_max3_f32 v4, v212, v213, v4
    v_add_f32_dpp v214, v243, v242 row_ror:8 row_mask:0xf bank_mask:0xf
    s_nop 2
    v_add_f32_dpp v215, v247, v246 row_ror:8 row_mask:0xf bank_mask:0xf
    v_max3_f32 v4, v214, v215, v4
    v_mov_b32 v5, v4
    s_nop 1
    v_permlane16_swap_b32 v4, v5
    v_max_f32 v4, v4, v5
    v_mov_b32 v5, v4
    s_nop 1
    v_permlane32_swap_b32 v4, v5
    v_max_f32 v4, v4, v5
    v_mov_b32 v16, 0x3f803f80
    v_mov_b32 v17, 0x3f803f80
    v_mov_b32 v18, 0x3f803f80
    v_mov_b32 v19, 0x3f803f80
    v_mul_f32 v4, s68, v4
    ds_write_b32 v8, v4 offset:16384
    v_fma_f32 v152, v152, s68, -v4
    v_fma_f32 v153, v153, s68, -v4
    v_fma_f32 v154, v154, s68, -v4
    v_fma_f32 v155, v155, s68, -v4
    v_fma_f32 v156, v156, s68, -v4
    v_fma_f32 v157, v157, s68, -v4
    v_fma_f32 v158, v158, s68, -v4
    v_fma_f32 v159, v159, s68, -v4
    v_exp_f32 v152, v152
    s_waitcnt lgkmcnt(0)
    v_readfirstlane_b32 s60, v252
    s_nop 1
    s_sub_u32 s61, s62, s60
    s_cmp_lg_u32 s60, 0
    s_cselect_b32 s61, s61, 0
    s_cmp_gt_u32 s61, 1031
    s_cselect_b64 vcc, -1, 0
    s_cbranch_vccnz L_th72
    s_waitcnt vmcnt(4)
L_th72:
    s_waitcnt vmcnt(7)
    s_mov_b32 s90, 0x8000
    buffer_load_dwordx4 v[56:59], v15, s[28:31], s90 offen offset:0 nt
    v_exp_f32 v153, v153
    v_exp_f32 v154, v154
    v_exp_f32 v155, v155
    v_exp_f32 v156, v156
    v_exp_f32 v157, v157
    v_exp_f32 v158, v158
    v_exp_f32 v159, v159
    v_fma_f32 v160, v160, s68, -v4
    v_fma_f32 v161, v161, s68, -v4
    v_fma_f32 v162, v162, s68, -v4
    v_fma_f32 v163, v163, s68, -v4
    v_fma_f32 v164, v164, s68, -v4
    v_fma_f32 v165, v165, s68, -v4
    v_fma_f32 v166, v166, s68, -v4
    v_fma_f32 v167, v167, s68, -v4
    v_exp_f32 v160, v160
    v_exp_f32 v161, v161
    v_exp_f32 v162, v162
    v_exp_f32 v163, v163
    v_exp_f32 v164, v164
    v_exp_f32 v165, v165
    v_exp_f32 v166, v166
    v_exp_f32 v167, v167
    v_cvt_pk_bf16_f32 v152, v152, v153
    v_cvt_pk_bf16_f32 v153, v154, v155
    s_cbranch_vccnz L_th73
    s_waitcnt vmcnt(4)
L_th73:
    s_waitcnt vmcnt(7)
    buffer_load_dwordx4 v[60:63], v15, s[28:31], s90 offen offset:1024 nt
    v_cvt_pk_bf16_f32 v154, v156, v157
    v_cvt_pk_bf16_f32 v155, v158, v159
    v_fma_f32 v168, v168, s68, -v4
    v_fma_f32 v169, v169, s68, -v4
    v_fma_f32 v170, v170, s68, -v4
    v_fma_f32 v171, v171, s68, -v4
    v_fma_f32 v172, v172, s68, -v4
    v_fma_f32 v173, v173, s68, -v4
    v_fma_f32 v174, v174, s68, -v4
    v_fma_f32 v175, v175, s68, -v4
    v_exp_f32 v168, v168
    v_exp_f32 v169, v169
    v_exp_f32 v170, v170
    v_exp_f32 v171, v171
    v_exp_f32 v172, v172
    v_exp_f32 v173, v173
    v_exp_f32 v174, v174
    v_exp_f32 v175, v175
    v_cvt_pk_bf16_f32 v156, v160, v161
    v_cvt_pk_bf16_f32 v157, v162, v163
    v_cvt_pk_bf16_f32 v158, v164, v165
    v_cvt_pk_bf16_f32 v159, v166, v167
    v_mfma_f32_16x16x32_bf16 v[248:251], v[16:19], v[152:155], 0
    v_fma_f32 v176, v176, s68, -v4
    v_fma_f32 v177, v177, s68, -v4
    v_fma_f32 v178, v178, s68, -v4
    v_fma_f32 v179, v179, s68, -v4
    v_fma_f32 v180, v180, s68, -v4
    v_fma_f32 v181, v181, s68, -v4
    v_fma_f32 v182, v182, s68, -v4
    v_fma_f32 v183, v183, s68, -v4
    s_cbranch_vccnz L_th74
    s_waitcnt vmcnt(4)
L_th74:
    s_waitcnt vmcnt(7)
    buffer_load_dwordx4 v[64:67], v15, s[28:31], s90 offen offset:2048 nt
    v_exp_f32 v176, v176
    v_exp_f32 v177, v177
    v_exp_f32 v178, v178
    v_exp_f32 v179, v179
    v_exp_f32 v180, v180
    v_exp_f32 v181, v181
    v_exp_f32 v182, v182
    v_exp_f32 v183, v183
    v_cvt_pk_bf16_f32 v160, v168, v169
    v_cvt_pk_bf16_f32 v161, v170, v171
    v_cvt_pk_bf16_f32 v162, v172, v173
    v_cvt_pk_bf16_f32 v163, v174, v175
    v_mfma_f32_16x16x32_bf16 v[248:251], v[16:19], v[156:159], v[248:251]
    v_fma_f32 v184, v184, s68, -v4
    v_fma_f32 v185, v185, s68, -v4
    v_fma_f32 v186, v186, s68, -v4
    v_fma_f32 v187, v187, s68, -v4
    v_fma_f32 v188, v188, s68, -v4
    v_fma_f32 v189, v189, s68, -v4
    v_fma_f32 v190, v190, s68, -v4
    v_fma_f32 v191, v191, s68, -v4
    v_exp_f32 v184, v184
    v_exp_f32 v185, v185
    v_exp_f32 v186, v186
    v_exp_f32 v187, v187
    v_exp_f32 v188, v188
    s_cbranch_vccnz L_th75
    s_waitcnt vmcnt(4)
L_th75:
    s_waitcnt vmcnt(7)
    buffer_load_dwordx4 v[68:71], v15, s[28:31], s90 offen offset:3072 nt
    s_memrealtime s[62:63]
    ds_read_b32 v252, v12 offset:16
    v_exp_f32 v189, v189
    v_exp_f32 v190, v190
    v_exp_f32 v191, v191
    v_cvt_pk_bf16_f32 v164, v176, v177
    v_cvt_pk_bf16_f32 v165, v178, v179
    v_cvt_pk_bf16_f32 v166, v180, v181
    v_cvt_pk_bf16_f32 v167, v182, v183
    v_mfma_f32_16x16x32_bf16 v[248:251], v[16:19], v[160:163], v[248:251]
    v_fma_f32 v192, v192, s68, -v4
    v_fma_f32 v193, v193, s68, -v4
    v_fma_f32 v194, v194, s68, -v4
    v_fma_f32 v195, v195, s68, -v4
    v_fma_f32 v196, v196, s68, -v4
    v_fma_f32 v197, v197, s68, -v4
    v_fma_f32 v198, v198, s68, -v4
    v_fma_f32 v199, v199, s68, -v4
    v_exp_f32 v192, v192
    v_exp_f32 v193, v193
    v_exp_f32 v194, v194
    v_exp_f32 v195, v195
    v_exp_f32 v196, v196
    v_exp_f32 v197, v197
    v_exp_f32 v198, v198
    v_exp_f32 v199, v199
    v_cvt_pk_bf16_f32 v168, v184, v185
    v_cvt_pk_bf16_f32 v169, v186, v187
    v_cvt_pk_bf16_f32 v170, v188, v189
    v_cvt_pk_bf16_f32 v171, v190, v191
    s_waitcnt lgkmcnt(0)
    v_readfirstlane_b32 s60, v252
    s_nop 1
    s_sub_u32 s61, s62, s60
    s_cmp_lg_u32 s60, 0
    s_cselect_b32 s61, s61, 0
    s_cmp_gt_u32 s61, 1086
    s_cselect_b64 vcc, -1, 0
    s_cbranch_vccnz L_th76
    s_waitcnt vmcnt(4)
L_th76:
    s_waitcnt vmcnt(7)
    s_mov_b32 s90, 0x9000
    buffer_load_dwordx4 v[72:75], v15, s[28:31], s90 offen offset:0 nt
    v_mfma_f32_16x16x32_bf16 v[248:251], v[16:19], v[164:167], v[248:251]
    v_fma_f32 v200, v200, s68, -v4
    v_fma_f32 v201, v201, s68, -v4
    v_fma_f32 v202, v202, s68, -v4
    v_fma_f32 v203, v203, s68, -v4
    v_fma_f32 v204, v204, s68, -v4
    v_fma_f32 v205, v205, s68, -v4
    v_fma_f32 v206, v206, s68, -v4
    v_fma_f32 v207, v207, s68, -v4
    v_exp_f32 v200, v200
    v_exp_f32 v201, v201
    v_exp_f32 v202, v202
    v_exp_f32 v203, v203
    v_exp_f32 v204, v204
    v_exp_f32 v205, v205
    v_exp_f32 v206, v206
    v_exp_f32 v207, v207
    v_cvt_pk_bf16_f32 v172, v192, v193
    v_cvt_pk_bf16_f32 v173, v194, v195
    v_cvt_pk_bf16_f32 v174, v196, v197
    v_cvt_pk_bf16_f32 v175, v198, v199
    v_mfma_f32_16x16x32_bf16 v[248:251], v[16:19], v[168:171], v[248:251]
    v_fma_f32 v208, v208, s68, -v4
    v_fma_f32 v209, v209, s68, -v4
    v_fma_f32 v210, v210, s68, -v4
    v_fma_f32 v211, v211, s68, -v4
    v_fma_f32 v212, v212, s68, -v4
    v_fma_f32 v213, v213, s68, -v4
    v_fma_f32 v214, v214, s68, -v4
    s_cbranch_vccnz L_th77
    s_waitcnt vmcnt(4)
L_th77:
    s_waitcnt vmcnt(7)
    buffer_load_dwordx4 v[76:79], v15, s[28:31], s90 offen offset:1024 nt
    v_fma_f32 v215, v215, s68, -v4
    v_exp_f32 v208, v208
    v_exp_f32 v209, v209
    v_exp_f32 v210, v210
    v_exp_f32 v211, v211
    v_exp_f32 v212, v212
    v_exp_f32 v213, v213
    v_exp_f32 v214, v214
    v_exp_f32 v215, v215
    v_cvt_pk_bf16_f32 v176, v200, v201
    v_cvt_pk_bf16_f32 v177, v202, v203
    v_cvt_pk_bf16_f32 v178, v204, v205
    v_cvt_pk_bf16_f32 v179, v206, v207
    v_mfma_f32_16x16x32_bf16 v[248:251], v[16:19], v[172:175], v[248:251]
    v_cvt_pk_bf16_f32 v180, v208, v209
    v_cvt_pk_bf16_f32 v181, v210, v211
    v_cvt_pk_bf16_f32 v182, v212, v213
    v_cvt_pk_bf16_f32 v183, v214, v215
    v_mfma_f32_16x16x32_bf16 v[248:251], v[16:19], v[176:179], v[248:251]
    s_nop 0
    v_mfma_f32_16x16x32_bf16 v[248:251], v[16:19], v[180:183], v[248:251]
    v_lshlrev_b32 v6, 4, v0
    s_nop 6
    ds_write_b32 v8, v248 offset:16640
    s_mov_b64 exec, 1
    ds_add_u32 v12, v13 offset:0
    s_mov_b64 exec, -1
    s_cbranch_vccnz L_th78
    s_waitcnt vmcnt(4)
L_th78:
    s_waitcnt vmcnt(7)
    buffer_load_dwordx4 v[80:83], v15, s[28:31], s90 offen offset:2048 nt
    v_perm_b32 v184, v28, v24, s42
    v_perm_b32 v188, v28, v24, s43
    v_perm_b32 v192, v29, v25, s42
    v_perm_b32 v196, v29, v25, s43
    v_perm_b32 v200, v30, v26, s42
    v_perm_b32 v204, v30, v26, s43
    v_perm_b32 v208, v31, v27, s42
    v_perm_b32 v212, v31, v27, s43
    v_perm_b32 v185, v36, v32, s42
    v_perm_b32 v189, v36, v32, s43
    v_perm_b32 v193, v37, v33, s42
    v_perm_b32 v197, v37, v33, s43
    v_perm_b32 v201, v38, v34, s42
    v_perm_b32 v205, v38, v34, s43
    v_perm_b32 v209, v39, v35, s42
    v_perm_b32 v213, v39, v35, s43
    v_perm_b32 v186, v44, v40, s42
    v_perm_b32 v190, v44, v40, s43
    v_perm_b32 v194, v45, v41, s42
    v_perm_b32 v198, v45, v41, s43
    v_perm_b32 v202, v46, v42, s42
    v_perm_b32 v206, v46, v42, s43
    v_perm_b32 v210, v47, v43, s42
    v_perm_b32 v214, v47, v43, s43
    s_cbranch_vccnz L_th79
    s_waitcnt vmcnt(4)
L_th79:
    s_waitcnt vmcnt(7)
    buffer_load_dwordx4 v[84:87], v15, s[28:31], s90 offen offset:3072 nt
    s_memrealtime s[62:63]
    ds_read_b32 v252, v12 offset:16
    v_perm_b32 v187, v52, v48, s42
    v_perm_b32 v191, v52, v48, s43
    v_perm_b32 v195, v53, v49, s42
    v_perm_b32 v199, v53, v49, s43
    v_perm_b32 v203, v54, v50, s42
    v_perm_b32 v207, v54, v50, s43
    v_perm_b32 v211, v55, v51, s42
    v_perm_b32 v215, v55, v51, s43
    v_mfma_f32_16x16x32_bf16 v[216:219], v[184:187], v[152:155], 0
    v_mfma_f32_16x16x32_bf16 v[220:223], v[188:191], v[152:155], 0
    v_mfma_f32_16x16x32_bf16 v[224:227], v[192:195], v[152:155], 0
    v_mfma_f32_16x16x32_bf16 v[228:231], v[196:199], v[152:155], 0
    v_mfma_f32_16x16x32_bf16 v[232:235], v[200:203], v[152:155], 0
    v_mfma_f32_16x16x32_bf16 v[236:239], v[204:207], v[152:155], 0
    v_mfma_f32_16x16x32_bf16 v[240:243], v[208:211], v[152:155], 0
    v_mfma_f32_16x16x32_bf16 v[244:247], v[212:215], v[152:155], 0
    s_waitcnt lgkmcnt(0)
    v_readfirstlane_b32 s60, v252
    s_nop 1
    s_sub_u32 s61, s62, s60
    s_cmp_lg_u32 s60, 0
    s_cselect_b32 s61, s61, 0
    s_cmp_gt_u32 s61, 1141
    s_cselect_b64 vcc, -1, 0
    s_cbranch_vccnz L_th80
    s_waitcnt vmcnt(4)
L_th80:
    s_waitcnt vmcnt(7)
    s_mov_b32 s90, 0x10000
    buffer_load_dwordx4 v[88:91], v2, s[28:31], s90 offen offset:0 nt
    s_cbranch_vccnz L_th81
    s_waitcnt vmcnt(4)
L_th81:
    s_waitcnt vmcnt(7)
    buffer_load_dwordx4 v[92:95], v2, s[28:31], s90 offen offset:1024 nt
    v_perm_b32 v184, v60, v56, s42
    v_perm_b32 v188, v60, v56, s43
    v_perm_b32 v192, v61, v57, s42
    v_perm_b32 v196, v61, v57, s43
    v_perm_b32 v200, v62, v58, s42
    v_perm_b32 v204, v62, v58, s43
    v_perm_b32 v208, v63, v59, s42
    v_perm_b32 v212, v63, v59, s43
    s_cbranch_vccnz L_th82
    s_waitcnt vmcnt(4)
L_th82:
    s_waitcnt vmcnt(7)
    buffer_load_dwordx4 v[96:99], v2, s[28:31], s90 offen offset:2048 nt
    s_cbranch_vccnz L_th83
    s_waitcnt vmcnt(4)
L_th83:
    s_waitcnt vmcnt(7)
    buffer_load_dwordx4 v[100:103], v2, s[28:31], s90 offen offset:3072 nt
    s_memrealtime s[62:63]
    ds_read_b32 v252, v12 offset:16
    v_perm_b32 v185, v68, v64, s42
    v_perm_b32 v189, v68, v64, s43
    v_perm_b32 v193, v69, v65, s42
    v_perm_b32 v197, v69, v65, s43
    v_perm_b32 v201, v70, v66, s42
    v_perm_b32 v205, v70, v66, s43
    v_perm_b32 v209, v71, v67, s42
    v_perm_b32 v213, v71, v67, s43
    s_waitcnt lgkmcnt(0)
    v_readfirstlane_b32 s60, v252
    s_nop 1
    s_sub_u32 s61, s62, s60
    s_cmp_lg_u32 s60, 0
    s_cselect_b32 s61, s61, 0
    s_cmp_gt_u32 s61, 1196
    s_cselect_b64 vcc, -1, 0
    s_cbranch_vccnz L_th84
    s_waitcnt vmcnt(4)
L_th84:
    s_waitcnt vmcnt(7)
    s_mov_b32 s90, 0x11000
    buffer_load_dwordx4 v[104:107], v2, s[28:31], s90 offen offset:0 nt
    s_cbranch_vccnz L_th85
    s_waitcnt vmcnt(4)
L_th85:
    s_waitcnt vmcnt(7)
    buffer_load_dwordx4 v[108:111], v2, s[28:31], s90 offen offset:1024 nt
    v_perm_b32 v186, v76, v72, s42
    v_perm_b32 v190, v76, v72, s43
    v_perm_b32 v194, v77, v73, s42
    v_perm_b32 v198, v77, v73, s43
    v_perm_b32 v202, v78, v74, s42
    v_perm_b32 v206, v78, v74, s43
    v_perm_b32 v210, v79, v75, s42
    v_perm_b32 v214, v79, v75, s43
    s_cbranch_vccnz L_th86
    s_waitcnt vmcnt(4)
L_th86:
    s_waitcnt vmcnt(7)
    buffer_load_dwordx4 v[112:115], v2, s[28:31], s90 offen offset:2048 nt
    s_cbranch_vccnz L_th87
    s_waitcnt vmcnt(4)
L_th87:
    s_waitcnt vmcnt(7)
    buffer_load_dwordx4 v[116:119], v2, s[28:31], s90 offen offset:3072 nt
    s_memrealtime s[62:63]
    ds_read_b32 v252, v12 offset:16
    v_perm_b32 v187, v84, v80, s42
    v_perm_b32 v191, v84, v80, s43
    v_perm_b32 v195, v85, v81, s42
    v_perm_b32 v199, v85, v81, s43
    v_perm_b32 v203, v86, v82, s42
    v_perm_b32 v207, v86, v82, s43
    v_perm_b32 v211, v87, v83, s42
    v_perm_b32 v215, v87, v83, s43
    v_mfma_f32_16x16x32_bf16 v[216:219], v[184:187], v[156:159], v[216:219]
    v_mfma_f32_16x16x32_bf16 v[220:223], v[188:191], v[156:159], v[220:223]
    v_mfma_f32_16x16x32_bf16 v[224:227], v[192:195], v[156:159], v[224:227]
    v_mfma_f32_16x16x32_bf16 v[228:231], v[196:199], v[156:159], v[228:231]
    v_mfma_f32_16x16x32_bf16 v[232:235], v[200:203], v[156:159], v[232:235]
    v_mfma_f32_16x16x32_bf16 v[236:239], v[204:207], v[156:159], v[236:239]
    v_mfma_f32_16x16x32_bf16 v[240:243], v[208:211], v[156:159], v[240:243]
    v_mfma_f32_16x16x32_bf16 v[244:247], v[212:215], v[156:159], v[244:247]
    s_waitcnt lgkmcnt(0)
    v_readfirstlane_b32 s60, v252
    s_nop 1
    s_sub_u32 s61, s62, s60
    s_cmp_lg_u32 s60, 0
    s_cselect_b32 s61, s61, 0
    s_cmp_gt_u32 s61, 1251
    s_cselect_b64 vcc, -1, 0
    s_cbranch_vccnz L_th88
    s_waitcnt vmcnt(4)
L_th88:
    s_waitcnt vmcnt(7)
    s_mov_b32 s90, 0x18000
    buffer_load_dwordx4 v[120:123], v15, s[28:31], s90 offen offset:0 nt
    s_cbranch_vccnz L_th89
    s_waitcnt vmcnt(4)
L_th89:
    s_waitcnt vmcnt(7)
    buffer_load_dwordx4 v[124:127], v15, s[28:31], s90 offen offset:1024 nt
    v_perm_b32 v184, v92, v88, s42
    v_perm_b32 v188, v92, v88, s43
    v_perm_b32 v192, v93, v89, s42
    v_perm_b32 v196, v93, v89, s43
    v_perm_b32 v200, v94, v90, s42
    v_perm_b32 v204, v94, v90, s43
    v_perm_b32 v208, v95, v91, s42
    v_perm_b32 v212, v95, v91, s43
    s_cbranch_vccnz L_th90
    s_waitcnt vmcnt(4)
L_th90:
    s_waitcnt vmcnt(7)
    buffer_load_dwordx4 v[128:131], v15, s[28:31], s90 offen offset:2048 nt
    s_cbranch_vccnz L_th91
    s_waitcnt vmcnt(4)
L_th91:
    s_waitcnt vmcnt(7)
    buffer_load_dwordx4 v[132:135], v15, s[28:31], s90 offen offset:3072 nt
    s_memrealtime s[62:63]
    ds_read_b32 v252, v12 offset:16
    v_perm_b32 v185, v100, v96, s42
    v_perm_b32 v189, v100, v96, s43
    v_perm_b32 v193, v101, v97, s42
    v_perm_b32 v197, v101, v97, s43
    v_perm_b32 v201, v102, v98, s42
    v_perm_b32 v205, v102, v98, s43
    v_perm_b32 v209, v103, v99, s42
    v_perm_b32 v213, v103, v99, s43
    s_waitcnt lgkmcnt(0)
    v_readfirstlane_b32 s60, v252
    s_nop 1
    s_sub_u32 s61, s62, s60
    s_cmp_lg_u32 s60, 0
    s_cselect_b32 s61, s61, 0
    s_cmp_gt_u32 s61, 1305
    s_cselect_b64 vcc, -1, 0
    s_cbranch_vccnz L_th92
    s_waitcnt vmcnt(4)
L_th92:
    s_waitcnt vmcnt(7)
    s_mov_b32 s90, 0x19000
    buffer_load_dwordx4 v[136:139], v15, s[28:31], s90 offen offset:0 nt
    s_cbranch_vccnz L_th93
    s_waitcnt vmcnt(4)
L_th93:
    s_waitcnt vmcnt(7)
    buffer_load_dwordx4 v[140:143], v15, s[28:31], s90 offen offset:1024 nt
    v_perm_b32 v186, v108, v104, s42
    v_perm_b32 v190, v108, v104, s43
    v_perm_b32 v194, v109, v105, s42
    v_perm_b32 v198, v109, v105, s43
    v_perm_b32 v202, v110, v106, s42
    v_perm_b32 v206, v110, v106, s43
    v_perm_b32 v210, v111, v107, s42
    v_perm_b32 v214, v111, v107, s43
    s_cbranch_vccnz L_th94
    s_waitcnt vmcnt(4)
L_th94:
    s_waitcnt vmcnt(7)
    buffer_load_dwordx4 v[144:147], v15, s[28:31], s90 offen offset:2048 nt
    s_cbranch_vccnz L_th95
    s_waitcnt vmcnt(4)
L_th95:
    s_waitcnt vmcnt(7)
    buffer_load_dwordx4 v[148:151], v15, s[28:31], s90 offen offset:3072 nt
    s_memrealtime s[62:63]
    ds_read_b32 v252, v12 offset:16
    v_perm_b32 v187, v116, v112, s42
    v_perm_b32 v191, v116, v112, s43
    v_perm_b32 v195, v117, v113, s42
    v_perm_b32 v199, v117, v113, s43
    v_perm_b32 v203, v118, v114, s42
    v_perm_b32 v207, v118, v114, s43
    v_perm_b32 v211, v119, v115, s42
    v_perm_b32 v215, v119, v115, s43
    v_mfma_f32_16x16x32_bf16 v[216:219], v[184:187], v[160:163], v[216:219]
    v_mfma_f32_16x16x32_bf16 v[220:223], v[188:191], v[160:163], v[220:223]
    v_mfma_f32_16x16x32_bf16 v[224:227], v[192:195], v[160:163], v[224:227]
    v_mfma_f32_16x16x32_bf16 v[228:231], v[196:199], v[160:163], v[228:231]
    v_mfma_f32_16x16x32_bf16 v[232:235], v[200:203], v[160:163], v[232:235]
    v_mfma_f32_16x16x32_bf16 v[236:239], v[204:207], v[160:163], v[236:239]
    v_mfma_f32_16x16x32_bf16 v[240:243], v[208:211], v[160:163], v[240:243]
    v_mfma_f32_16x16x32_bf16 v[244:247], v[212:215], v[160:163], v[244:247]
    s_waitcnt lgkmcnt(0)
    v_readfirstlane_b32 s60, v252
    s_nop 1
    s_sub_u32 s61, s62, s60
    s_cmp_lg_u32 s60, 0
    s_cselect_b32 s61, s61, 0
    s_cmp_gt_u32 s61, 1360
    s_cselect_b64 vcc, -1, 0
    s_cbranch_vccnz L_th96
    s_waitcnt vmcnt(4)
L_th96:
    s_waitcnt vmcnt(7)
    s_mov_b32 s90, 0x20000
    buffer_load_dwordx4 v[24:27], v2, s[28:31], s90 offen offset:0 nt
    s_mov_b64 exec, 1
    ds_add_u32 v12, v13 offset:4
    s_mov_b64 exec, -1
    s_cbranch_vccnz L_th97
    s_waitcnt vmcnt(4)
L_th97:
    s_waitcnt vmcnt(7)
    buffer_load_dwordx4 v[28:31], v2, s[28:31], s90 offen offset:1024 nt
    v_perm_b32 v184, v124, v120, s42
    v_perm_b32 v188, v124, v120, s43
    v_perm_b32 v192, v125, v121, s42
    v_perm_b32 v196, v125, v121, s43
    v_perm_b32 v200, v126, v122, s42
    v_perm_b32 v204, v126, v122, s43
    v_perm_b32 v208, v127, v123, s42
    v_perm_b32 v212, v127, v123, s43
    s_cbranch_vccnz L_th98
    s_waitcnt vmcnt(4)
L_th98:
    s_waitcnt vmcnt(7)
    buffer_load_dwordx4 v[32:35], v2, s[28:31], s90 offen offset:2048 nt
    s_cbranch_vccnz L_th99
    s_waitcnt vmcnt(4)
L_th99:
    s_waitcnt vmcnt(7)
    buffer_load_dwordx4 v[36:39], v2, s[28:31], s90 offen offset:3072 nt
    s_memrealtime s[62:63]
    ds_read_b32 v252, v12 offset:16
    v_perm_b32 v185, v132, v128, s42
    v_perm_b32 v189, v132, v128, s43
    v_perm_b32 v193, v133, v129, s42
    v_perm_b32 v197, v133, v129, s43
    v_perm_b32 v201, v134, v130, s42
    v_perm_b32 v205, v134, v130, s43
    v_perm_b32 v209, v135, v131, s42
    v_perm_b32 v213, v135, v131, s43
    s_waitcnt lgkmcnt(0)
    v_readfirstlane_b32 s60, v252
    s_nop 1
    s_sub_u32 s61, s62, s60
    s_cmp_lg_u32 s60, 0
    s_cselect_b32 s61, s61, 0
    s_cmp_gt_u32 s61, 1415
    s_cselect_b64 vcc, -1, 0
    s_cbranch_vccnz L_th100
    s_waitcnt vmcnt(4)
L_th100:
    s_waitcnt vmcnt(7)
    s_mov_b32 s90, 0x21000
    buffer_load_dwordx4 v[40:43], v2, s[28:31], s90 offen offset:0 nt
    s_cbranch_vccnz L_th101
    s_waitcnt vmcnt(4)
L_th101:
    s_waitcnt vmcnt(7)
    buffer_load_dwordx4 v[44:47], v2, s[28:31], s90 offen offset:1024 nt
    v_perm_b32 v186, v140, v136, s42
    v_perm_b32 v190, v140, v136, s43
    v_perm_b32 v194, v141, v137, s42
    v_perm_b32 v198, v141, v137, s43
    v_perm_b32 v202, v142, v138, s42
    v_perm_b32 v206, v142, v138, s43
    v_perm_b32 v210, v143, v139, s42
    v_perm_b32 v214, v143, v139, s43
    s_cbranch_vccnz L_th102
    s_waitcnt vmcnt(4)
L_th102:
    s_waitcnt vmcnt(7)
    buffer_load_dwordx4 v[48:51], v2, s[28:31], s90 offen offset:2048 nt
    s_cbranch_vccnz L_th103
    s_waitcnt vmcnt(4)
L_th103:
    s_waitcnt vmcnt(7)
    buffer_load_dwordx4 v[52:55], v2, s[28:31], s90 offen offset:3072 nt
    s_memrealtime s[62:63]
    ds_read_b32 v252, v12 offset:16
    v_perm_b32 v187, v148, v144, s42
    v_perm_b32 v191, v148, v144, s43
    v_perm_b32 v195, v149, v145, s42
    v_perm_b32 v199, v149, v145, s43
    v_perm_b32 v203, v150, v146, s42
    v_perm_b32 v207, v150, v146, s43
    v_perm_b32 v211, v151, v147, s42
    v_perm_b32 v215, v151, v147, s43
    v_mfma_f32_16x16x32_bf16 v[216:219], v[184:187], v[164:167], v[216:219]
    v_mfma_f32_16x16x32_bf16 v[220:223], v[188:191], v[164:167], v[220:223]
    v_mfma_f32_16x16x32_bf16 v[224:227], v[192:195], v[164:167], v[224:227]
    v_mfma_f32_16x16x32_bf16 v[228:231], v[196:199], v[164:167], v[228:231]
    v_mfma_f32_16x16x32_bf16 v[232:235], v[200:203], v[164:167], v[232:235]
    v_mfma_f32_16x16x32_bf16 v[236:239], v[204:207], v[164:167], v[236:239]
    v_mfma_f32_16x16x32_bf16 v[240:243], v[208:211], v[164:167], v[240:243]
    v_mfma_f32_16x16x32_bf16 v[244:247], v[212:215], v[164:167], v[244:247]
    s_waitcnt lgkmcnt(0)
    v_readfirstlane_b32 s60, v252
    s_nop 1
    s_sub_u32 s61, s62, s60
    s_cmp_lg_u32 s60, 0
    s_cselect_b32 s61, s61, 0
    s_cmp_gt_u32 s61, 1470
    s_cselect_b64 vcc, -1, 0
    s_cbranch_vccnz L_th104
    s_waitcnt vmcnt(4)
L_th104:
    s_waitcnt vmcnt(7)
    s_mov_b32 s90, 0x28000
    buffer_load_dwordx4 v[56:59], v15, s[28:31], s90 offen offset:0 nt
    s_cbranch_vccnz L_th105
    s_waitcnt vmcnt(4)
L_th105:
    s_waitcnt vmcnt(7)
    buffer_load_dwordx4 v[60:63], v15, s[28:31], s90 offen offset:1024 nt
    v_perm_b32 v184, v28, v24, s42
    v_perm_b32 v188, v28, v24, s43
    v_perm_b32 v192, v29, v25, s42
    v_perm_b32 v196, v29, v25, s43
    v_perm_b32 v200, v30, v26, s42
    v_perm_b32 v204, v30, v26, s43
    v_perm_b32 v208, v31, v27, s42
    v_perm_b32 v212, v31, v27, s43
    s_cbranch_vccnz L_th106
    s_waitcnt vmcnt(4)
L_th106:
    s_waitcnt vmcnt(7)
    buffer_load_dwordx4 v[64:67], v15, s[28:31], s90 offen offset:2048 nt
    s_cbranch_vccnz L_th107
    s_waitcnt vmcnt(4)
L_th107:
    s_waitcnt vmcnt(7)
    buffer_load_dwordx4 v[68:71], v15, s[28:31], s90 offen offset:3072 nt
    s_memrealtime s[62:63]
    ds_read_b32 v252, v12 offset:16
    v_perm_b32 v185, v36, v32, s42
    v_perm_b32 v189, v36, v32, s43
    v_perm_b32 v193, v37, v33, s42
    v_perm_b32 v197, v37, v33, s43
    v_perm_b32 v201, v38, v34, s42
    v_perm_b32 v205, v38, v34, s43
    v_perm_b32 v209, v39, v35, s42
    v_perm_b32 v213, v39, v35, s43
    s_waitcnt lgkmcnt(0)
    v_readfirstlane_b32 s60, v252
    s_nop 1
    s_sub_u32 s61, s62, s60
    s_cmp_lg_u32 s60, 0
    s_cselect_b32 s61, s61, 0
    s_cmp_gt_u32 s61, 1525
    s_cselect_b64 vcc, -1, 0
    s_cbranch_vccnz L_th108
    s_waitcnt vmcnt(4)
L_th108:
    s_waitcnt vmcnt(7)
    s_mov_b32 s90, 0x29000
    buffer_load_dwordx4 v[72:75], v15, s[28:31], s90 offen offset:0 nt
    s_cbranch_vccnz L_th109
    s_waitcnt vmcnt(4)
L_th109:
    s_waitcnt vmcnt(7)
    buffer_load_dwordx4 v[76:79], v15, s[28:31], s90 offen offset:1024 nt
    v_perm_b32 v186, v44, v40, s42
    v_perm_b32 v190, v44, v40, s43
    v_perm_b32 v194, v45, v41, s42
    v_perm_b32 v198, v45, v41, s43
    v_perm_b32 v202, v46, v42, s42
    v_perm_b32 v206, v46, v42, s43
    v_perm_b32 v210, v47, v43, s42
    v_perm_b32 v214, v47, v43, s43
    s_cbranch_vccnz L_th110
    s_waitcnt vmcnt(4)
L_th110:
    s_waitcnt vmcnt(7)
    buffer_load_dwordx4 v[80:83], v15, s[28:31], s90 offen offset:2048 nt
    s_cbranch_vccnz L_th111
    s_waitcnt vmcnt(4)
L_th111:
    s_waitcnt vmcnt(7)
    buffer_load_dwordx4 v[84:87], v15, s[28:31], s90 offen offset:3072 nt
    s_memrealtime s[62:63]
    ds_read_b32 v252, v12 offset:16
    v_perm_b32 v187, v52, v48, s42
    v_perm_b32 v191, v52, v48, s43
    v_perm_b32 v195, v53, v49, s42
    v_perm_b32 v199, v53, v49, s43
    v_perm_b32 v203, v54, v50, s42
    v_perm_b32 v207, v54, v50, s43
    v_perm_b32 v211, v55, v51, s42
    v_perm_b32 v215, v55, v51, s43
    v_mfma_f32_16x16x32_bf16 v[216:219], v[184:187], v[168:171], v[216:219]
    v_mfma_f32_16x16x32_bf16 v[220:223], v[188:191], v[168:171], v[220:223]
    v_mfma_f32_16x16x32_bf16 v[224:227], v[192:195], v[168:171], v[224:227]
    v_mfma_f32_16x16x32_bf16 v[228:231], v[196:199], v[168:171], v[228:231]
    v_mfma_f32_16x16x32_bf16 v[232:235], v[200:203], v[168:171], v[232:235]
    v_mfma_f32_16x16x32_bf16 v[236:239], v[204:207], v[168:171], v[236:239]
    v_mfma_f32_16x16x32_bf16 v[240:243], v[208:211], v[168:171], v[240:243]
    v_mfma_f32_16x16x32_bf16 v[244:247], v[212:215], v[168:171], v[244:247]
    s_waitcnt lgkmcnt(0)
    v_readfirstlane_b32 s60, v252
    s_nop 1
    s_sub_u32 s61, s62, s60
    s_cmp_lg_u32 s60, 0
    s_cselect_b32 s61, s61, 0
    s_cmp_gt_u32 s61, 1579
    s_cselect_b64 vcc, -1, 0
    s_cbranch_vccnz L_th112
    s_waitcnt vmcnt(4)
L_th112:
    s_waitcnt vmcnt(7)
    s_mov_b32 s90, 0x30000
    buffer_load_dwordx4 v[88:91], v2, s[28:31], s90 offen offset:0 nt
    s_cbranch_vccnz L_th113
    s_waitcnt vmcnt(4)
L_th113:
    s_waitcnt vmcnt(7)
    buffer_load_dwordx4 v[92:95], v2, s[28:31], s90 offen offset:1024 nt
    v_perm_b32 v184, v60, v56, s42
    v_perm_b32 v188, v60, v56, s43
    v_perm_b32 v192, v61, v57, s42
    v_perm_b32 v196, v61, v57, s43
    v_perm_b32 v200, v62, v58, s42
    v_perm_b32 v204, v62, v58, s43
    v_perm_b32 v208, v63, v59, s42
    v_perm_b32 v212, v63, v59, s43
    s_cbranch_vccnz L_th114
    s_waitcnt vmcnt(4)
L_th114:
    s_waitcnt vmcnt(7)
    buffer_load_dwordx4 v[96:99], v2, s[28:31], s90 offen offset:2048 nt
    s_cbranch_vccnz L_th115
    s_waitcnt vmcnt(4)
L_th115:
    s_waitcnt vmcnt(7)
    buffer_load_dwordx4 v[100:103], v2, s[28:31], s90 offen offset:3072 nt
    s_memrealtime s[62:63]
    ds_read_b32 v252, v12 offset:16
    v_perm_b32 v185, v68, v64, s42
    v_perm_b32 v189, v68, v64, s43
    v_perm_b32 v193, v69, v65, s42
    v_perm_b32 v197, v69, v65, s43
    v_perm_b32 v201, v70, v66, s42
    v_perm_b32 v205, v70, v66, s43
    v_perm_b32 v209, v71, v67, s42
    v_perm_b32 v213, v71, v67, s43
    s_waitcnt lgkmcnt(0)
    v_readfirstlane_b32 s60, v252
    s_nop 1
    s_sub_u32 s61, s62, s60
    s_cmp_lg_u32 s60, 0
    s_cselect_b32 s61, s61, 0
    s_cmp_gt_u32 s61, 1634
    s_cselect_b64 vcc, -1, 0
    s_cbranch_vccnz L_th116
    s_waitcnt vmcnt(4)
L_th116:
    s_waitcnt vmcnt(7)
    s_mov_b32 s90, 0x31000
    buffer_load_dwordx4 v[104:107], v2, s[28:31], s90 offen offset:0 nt
    s_cbranch_vccnz L_th117
    s_waitcnt vmcnt(4)
L_th117:
    s_waitcnt vmcnt(7)
    buffer_load_dwordx4 v[108:111], v2, s[28:31], s90 offen offset:1024 nt
    v_perm_b32 v186, v76, v72, s42
    v_perm_b32 v190, v76, v72, s43
    v_perm_b32 v194, v77, v73, s42
    v_perm_b32 v198, v77, v73, s43
    v_perm_b32 v202, v78, v74, s42
    v_perm_b32 v206, v78, v74, s43
    v_perm_b32 v210, v79, v75, s42
    v_perm_b32 v214, v79, v75, s43
    s_cbranch_vccnz L_th118
    s_waitcnt vmcnt(4)
L_th118:
    s_waitcnt vmcnt(7)
    buffer_load_dwordx4 v[112:115], v2, s[28:31], s90 offen offset:2048 nt
    s_cbranch_vccnz L_th119
    s_waitcnt vmcnt(4)
L_th119:
    s_waitcnt vmcnt(7)
    buffer_load_dwordx4 v[116:119], v2, s[28:31], s90 offen offset:3072 nt
    v_perm_b32 v187, v84, v80, s42
    v_perm_b32 v191, v84, v80, s43
    v_perm_b32 v195, v85, v81, s42
    v_perm_b32 v199, v85, v81, s43
    v_perm_b32 v203, v86, v82, s42
    v_perm_b32 v207, v86, v82, s43
    v_perm_b32 v211, v87, v83, s42
    v_perm_b32 v215, v87, v83, s43
    v_mfma_f32_16x16x32_bf16 v[216:219], v[184:187], v[172:175], v[216:219]
    v_mfma_f32_16x16x32_bf16 v[220:223], v[188:191], v[172:175], v[220:223]
    v_mfma_f32_16x16x32_bf16 v[224:227], v[192:195], v[172:175], v[224:227]
    v_mfma_f32_16x16x32_bf16 v[228:231], v[196:199], v[172:175], v[228:231]
    v_mfma_f32_16x16x32_bf16 v[232:235], v[200:203], v[172:175], v[232:235]
    v_mfma_f32_16x16x32_bf16 v[236:239], v[204:207], v[172:175], v[236:239]
    v_mfma_f32_16x16x32_bf16 v[240:243], v[208:211], v[172:175], v[240:243]
    v_mfma_f32_16x16x32_bf16 v[244:247], v[212:215], v[172:175], v[244:247]
    s_waitcnt vmcnt(7)
    s_mov_b32 s90, 0x38000
    buffer_load_dwordx4 v[120:123], v15, s[28:31], s90 offen offset:0 nt
    v_xor_b32 v153, 16, v3
    v_xor_b32 v154, 32, v3
    v_xor_b32 v155, 48, v3
    s_waitcnt vmcnt(7)
    buffer_load_dwordx4 v[124:127], v15, s[28:31], s90 offen offset:1024 nt
    v_perm_b32 v184, v92, v88, s42
    v_perm_b32 v188, v92, v88, s43
    v_perm_b32 v192, v93, v89, s42
    v_perm_b32 v196, v93, v89, s43
    v_perm_b32 v200, v94, v90, s42
    v_perm_b32 v204, v94, v90, s43
    v_perm_b32 v208, v95, v91, s42
    v_perm_b32 v212, v95, v91, s43
    s_waitcnt vmcnt(7)
    buffer_load_dwordx4 v[128:131], v15, s[28:31], s90 offen offset:2048 nt
    s_waitcnt vmcnt(7)
    buffer_load_dwordx4 v[132:135], v15, s[28:31], s90 offen offset:3072 nt
    v_perm_b32 v185, v100, v96, s42
    v_perm_b32 v189, v100, v96, s43
    v_perm_b32 v193, v101, v97, s42
    v_perm_b32 v197, v101, v97, s43
    v_perm_b32 v201, v102, v98, s42
    v_perm_b32 v205, v102, v98, s43
    v_perm_b32 v209, v103, v99, s42
    v_perm_b32 v213, v103, v99, s43
    s_waitcnt vmcnt(7)
    s_mov_b32 s90, 0x39000
    buffer_load_dwordx4 v[136:139], v15, s[28:31], s90 offen offset:0 nt
    s_waitcnt vmcnt(7)
    buffer_load_dwordx4 v[140:143], v15, s[28:31], s90 offen offset:1024 nt
    v_perm_b32 v186, v108, v104, s42
    v_perm_b32 v190, v108, v104, s43
    v_perm_b32 v194, v109, v105, s42
    v_perm_b32 v198, v109, v105, s43
    v_perm_b32 v202, v110, v106, s42
    v_perm_b32 v206, v110, v106, s43
    v_perm_b32 v210, v111, v107, s42
    v_perm_b32 v214, v111, v107, s43
    s_waitcnt vmcnt(7)
    buffer_load_dwordx4 v[144:147], v15, s[28:31], s90 offen offset:2048 nt
    s_waitcnt vmcnt(7)
    buffer_load_dwordx4 v[148:151], v15, s[28:31], s90 offen offset:3072 nt
    v_perm_b32 v187, v116, v112, s42
    v_perm_b32 v191, v116, v112, s43
    v_perm_b32 v195, v117, v113, s42
    v_perm_b32 v199, v117, v113, s43
    v_perm_b32 v203, v118, v114, s42
    v_perm_b32 v207, v118, v114, s43
    v_perm_b32 v211, v119, v115, s42
    v_perm_b32 v215, v119, v115, s43
    v_mfma_f32_16x16x32_bf16 v[216:219], v[184:187], v[176:179], v[216:219]
    v_mfma_f32_16x16x32_bf16 v[220:223], v[188:191], v[176:179], v[220:223]
    v_mfma_f32_16x16x32_bf16 v[224:227], v[192:195], v[176:179], v[224:227]
    v_mfma_f32_16x16x32_bf16 v[228:231], v[196:199], v[176:179], v[228:231]
    v_mfma_f32_16x16x32_bf16 v[232:235], v[200:203], v[176:179], v[232:235]
    v_mfma_f32_16x16x32_bf16 v[236:239], v[204:207], v[176:179], v[236:239]
    v_mfma_f32_16x16x32_bf16 v[240:243], v[208:211], v[176:179], v[240:243]
    v_mfma_f32_16x16x32_bf16 v[244:247], v[212:215], v[176:179], v[244:247]
    s_waitcnt vmcnt(6)
    v_perm_b32 v184, v124, v120, s42
    v_perm_b32 v188, v124, v120, s43
    v_perm_b32 v192, v125, v121, s42
    v_perm_b32 v196, v125, v121, s43
    v_perm_b32 v200, v126, v122, s42
    v_perm_b32 v204, v126, v122, s43
    v_perm_b32 v208, v127, v123, s42
    v_perm_b32 v212, v127, v123, s43
    s_waitcnt vmcnt(4)
    v_perm_b32 v185, v132, v128, s42
    v_perm_b32 v189, v132, v128, s43
    v_perm_b32 v193, v133, v129, s42
    v_perm_b32 v197, v133, v129, s43
    v_perm_b32 v201, v134, v130, s42
    v_perm_b32 v205, v134, v130, s43
    v_perm_b32 v209, v135, v131, s42
    v_perm_b32 v213, v135, v131, s43
    s_mov_b64 exec, 1
    ds_add_u32 v12, v13 offset:4
    s_mov_b64 exec, -1
    s_waitcnt vmcnt(2)
    v_perm_b32 v186, v140, v136, s42
    v_perm_b32 v190, v140, v136, s43
    v_perm_b32 v194, v141, v137, s42
    v_perm_b32 v198, v141, v137, s43
    v_perm_b32 v202, v142, v138, s42
    v_perm_b32 v206, v142, v138, s43
    v_perm_b32 v210, v143, v139, s42
    v_perm_b32 v214, v143, v139, s43
    s_waitcnt vmcnt(0)
    v_perm_b32 v187, v148, v144, s42
    v_perm_b32 v203, v150, v146, s42
    v_perm_b32 v191, v148, v144, s43
    v_mfma_f32_16x16x32_bf16 v[216:219], v[184:187], v[180:183], v[216:219]
    v_perm_b32 v207, v150, v146, s43
    v_mfma_f32_16x16x32_bf16 v[232:235], v[200:203], v[180:183], v[232:235]
    v_perm_b32 v195, v149, v145, s42
    v_mfma_f32_16x16x32_bf16 v[220:223], v[188:191], v[180:183], v[220:223]
    v_perm_b32 v211, v151, v147, s42
    v_mfma_f32_16x16x32_bf16 v[236:239], v[204:207], v[180:183], v[236:239]
    v_perm_b32 v199, v149, v145, s43
    v_mfma_f32_16x16x32_bf16 v[224:227], v[192:195], v[180:183], v[224:227]
    v_perm_b32 v215, v151, v147, s43
    v_mfma_f32_16x16x32_bf16 v[240:243], v[208:211], v[180:183], v[240:243]
    v_mfma_f32_16x16x32_bf16 v[228:231], v[196:199], v[180:183], v[228:231]
    v_mfma_f32_16x16x32_bf16 v[244:247], v[212:215], v[180:183], v[244:247]
    v_mov_b32_dpp v216, v232 row_shr:8 row_mask:0xf bank_mask:0xc
    v_mov_b32_dpp v217, v233 row_shr:8 row_mask:0xf bank_mask:0xc
    v_mov_b32_dpp v218, v234 row_shr:8 row_mask:0xf bank_mask:0xc
    v_mov_b32_dpp v219, v235 row_shr:8 row_mask:0xf bank_mask:0xc
    ds_write_b128 v3, v[216:219]
    v_mov_b32_dpp v220, v236 row_shr:8 row_mask:0xf bank_mask:0xc
    v_mov_b32_dpp v221, v237 row_shr:8 row_mask:0xf bank_mask:0xc
    v_mov_b32_dpp v222, v238 row_shr:8 row_mask:0xf bank_mask:0xc
    v_mov_b32_dpp v223, v239 row_shr:8 row_mask:0xf bank_mask:0xc
    ds_write_b128 v153, v[220:223]
    v_mov_b32_dpp v224, v240 row_shr:8 row_mask:0xf bank_mask:0xc
    v_mov_b32_dpp v225, v241 row_shr:8 row_mask:0xf bank_mask:0xc
    v_mov_b32_dpp v226, v242 row_shr:8 row_mask:0xf bank_mask:0xc
    v_mov_b32_dpp v227, v243 row_shr:8 row_mask:0xf bank_mask:0xc
    ds_write_b128 v154, v[224:227]
    v_mov_b32_dpp v228, v244 row_shr:8 row_mask:0xf bank_mask:0xc
    v_mov_b32_dpp v229, v245 row_shr:8 row_mask:0xf bank_mask:0xc
    v_mov_b32_dpp v230, v246 row_shr:8 row_mask:0xf bank_mask:0xc
    v_mov_b32_dpp v231, v247 row_shr:8 row_mask:0xf bank_mask:0xc
    ds_write_b128 v155, v[228:231]
    s_waitcnt lgkmcnt(0)
    s_barrier
    ds_read_b128 v[40:43], v7 offset:16896
    ds_read_b128 v[24:27], v6 offset:0
    ds_read_b128 v[28:31], v6 offset:4096
    ds_read_b128 v[32:35], v6 offset:8192
    ds_read_b128 v[36:39], v6 offset:12288
    ds_read_b32 v5, v12 offset:8
    s_waitcnt lgkmcnt(4)
    v_pk_mul_f32 v[24:25], v[24:25], v[40:41] op_sel:[0,0] op_sel_hi:[1,0]
    v_pk_mul_f32 v[26:27], v[26:27], v[40:41] op_sel:[0,0] op_sel_hi:[1,0]
    s_waitcnt lgkmcnt(3)
    v_pk_fma_f32 v[24:25], v[28:29], v[40:41], v[24:25] op_sel:[0,1,0] op_sel_hi:[1,1,1]
    v_pk_fma_f32 v[26:27], v[30:31], v[40:41], v[26:27] op_sel:[0,1,0] op_sel_hi:[1,1,1]
    s_waitcnt lgkmcnt(2)
    v_pk_fma_f32 v[24:25], v[32:33], v[42:43], v[24:25] op_sel:[0,0,0] op_sel_hi:[1,0,1]
    v_pk_fma_f32 v[26:27], v[34:35], v[42:43], v[26:27] op_sel:[0,0,0] op_sel_hi:[1,0,1]
    s_waitcnt lgkmcnt(1)
    v_pk_fma_f32 v[24:25], v[36:37], v[42:43], v[24:25] op_sel:[0,1,0] op_sel_hi:[1,1,1]
    v_pk_fma_f32 v[26:27], v[38:39], v[42:43], v[26:27] op_sel:[0,1,0] op_sel_hi:[1,1,1]
    v_min_u32 v24, s101, v24
    v_min_u32 v25, s101, v25
    v_min_u32 v26, s101, v26
    v_min_u32 v27, s101, v27
    buffer_store_dwordx4 v[24:27], v9, s[36:39], s92 offen
    s_waitcnt lgkmcnt(0)
    v_readfirstlane_b32 s94, v5
    s_add_u32 s92, s92, 0x100000
    s_nop 1
    s_cmp_eq_u32 s94, 1
    s_cbranch_scc1 L_fin
    buffer_store_dwordx4 v[24:27], v9, s[36:39], s92 offen sc1
    s_waitcnt vmcnt(0)
    s_mov_b64 exec, 1
    ds_add_u32 v12, v13 offset:12
    s_mov_b64 exec, -1
    s_branch L_fin
L_helper:
    s_and_b32 s22, s2, 7
    s_lshr_b32 s23, s2, 3
    v_lshrrev_b32 v10, 6, v0
    v_and_b32 v11, 63, v0
    s_lshr_b32 s40, s23, 2
    s_and_b32 s41, s23, 3
    s_lshl_b32 s100, s22, 5
    s_lshl_b32 s65, s22, 12
    s_add_u32 s65, s65, 0x200000
    s_lshl_b32 s95, s23, 7
    s_add_u32 s93, s65, s95
    s_lshl_b32 s95, s40, 4
    s_add_u32 s65, s65, s95
    s_lshl_b32 s60, s22, 3
    s_add_u32 s60, s60, s40
    s_lshl_b32 s60, s60, 8
    s_lshl_b32 s61, s22, 8
    s_lshl_b32 s67, s41, 6
    s_add_u32 s63, s61, s67
    s_add_u32 s66, s60, s67
    s_lshl_b32 s64, s22, 17
    s_lshl_b32 s67, s23, 12
    s_add_u32 s64, s64, s67
    s_lshr_b32 s62, s22, 2
    s_lshl_b32 s62, s62, 4
    s_mov_b32 s38, 0x208000
    s_mov_b32 s39, 0x20000
    s_mov_b32 s46, 0x4000
    s_mov_b32 s47, 0x20000
    s_mov_b32 s98, 0x100
    s_mov_b32 s99, 0x20000
    v_mov_b32 v30, 0
    v_and_b32 v5, 7, v11
    v_lshlrev_b32 v88, 4, v5
    v_xor_b32 v31, s40, v5
    v_lshlrev_b32 v31, 1, v31
    v_bfe_u32 v6, v11, 3, 2
    v_lshl_add_u32 v89, v6, 4, v31
    v_bfe_u32 v6, v11, 4, 1
    v_lshl_add_u32 v31, v6, 5, v31
    v_bfe_u32 v6, v11, 5, 1
    v_lshl_add_u32 v31, v6, 4, v31
    v_lshrrev_b32 v6, 3, v11
    v_lshlrev_b32 v32, 9, v6
    v_lshl_add_u32 v32, v5, 4, v32
    v_lshlrev_b32 v90, 4, v6
    v_and_b32 v29, 31, v11
    v_lshlrev_b32 v29, 7, v29
    v_and_b32 v36, 15, v11
    v_lshlrev_b32 v36, 4, v36
    s_mov_b32 s58, 1000000
    s_getreg_b32 s57, hwreg(HW_REG_XCC_ID, 0, 4)
    s_waitcnt lgkmcnt(0)
    s_load_dword s56, s[14:15], 0
    s_add_u32 s12, s12, s63
    s_addc_u32 s13, s13, 0
    s_load_dwordx8 s[24:31], s[12:13], 0
    s_load_dwordx8 s[48:55], s[12:13], 32
    s_mov_b32 s36, s20
    s_mov_b32 s37, s21
    s_mov_b32 s44, s16
    s_mov_b32 s45, s17
    s_mov_b32 s96, s18
    s_mov_b32 s97, s19
    s_cmp_eq_u32 s23, 0
    s_cbranch_scc0 L_nolead
    v_mov_b32 v80, -1
    v_mov_b32 v81, -1
    v_mov_b32 v82, -1
    v_mov_b32 v83, -1
    v_lshlrev_b32 v37, 4, v11
    s_or_b32 s94, s86, 1
    v_mov_b32 v35, s94
    s_setprio 3
    buffer_store_dwordx4 v[80:83], v37, s[36:39], s93 offen offset:0 sc1
    buffer_store_dwordx4 v[80:83], v37, s[36:39], s93 offen offset:1024 sc1
    buffer_store_dwordx4 v[80:83], v37, s[36:39], s93 offen offset:2048 sc1
    buffer_store_dwordx4 v[80:83], v37, s[36:39], s93 offen offset:3072 sc1
    s_waitcnt vmcnt(0)
    s_mov_b64 exec, 1
    buffer_store_dword v35, v30, s[96:99], s100 offen sc1
    s_mov_b64 exec, -1
    s_setprio 0
L_nolead:
    s_waitcnt lgkmcnt(0)
    v_writelane_b32 v5, s24, 0
    v_writelane_b32 v5, s25, 1
    v_writelane_b32 v5, s26, 2
    v_writelane_b32 v5, s27, 3
    v_writelane_b32 v5, s28, 4
    v_writelane_b32 v5, s29, 5
    v_writelane_b32 v5, s30, 6
    v_writelane_b32 v5, s31, 7
    v_writelane_b32 v5, s48, 8
    v_writelane_b32 v5, s49, 9
    v_writelane_b32 v5, s50, 10
    v_writelane_b32 v5, s51, 11
    v_writelane_b32 v5, s52, 12
    v_writelane_b32 v5, s53, 13
    v_writelane_b32 v5, s54, 14
    v_writelane_b32 v5, s55, 15
    v_and_b32 v6, 0x3c, v89
    ds_bpermute_b32 v28, v6, v5
    v_and_b32 v6, 2, v89
    v_lshlrev_b32 v6, 3, v6
    s_lshr_b32 s56, s56, s62
    s_lshl_b32 s56, s56, 16
    v_sub_f32 v26, 1.0, s56
    v_mul_f32 v26, 0xceabfb8f, v26
    s_lshl_b32 s94, s40, 2
    s_waitcnt lgkmcnt(0)
    v_lshrrev_b32 v28, v6, v28
    v_lshlrev_b32 v28, 16, v28
    v_mov_b32 v89, s94
    s_mov_b32 s101, 0xfffffffe
    v_and_b32 v37, 7, v11
    v_lshlrev_b32 v37, 5, v37
    s_sleep 40
L_lead:
    s_sub_u32 s58, s58, 1
    s_cbranch_scc1 L_giveup
    s_sleep 16
    s_setprio 3
    buffer_load_dword v35, v37, s[96:99], 0 offen sc1
    s_waitcnt vmcnt(0)
    s_setprio 0
    v_cmp_eq_u32 vcc, 0, v35
    s_cbranch_vccnz L_lead
    v_subrev_u32 v35, s86, v35
    s_nop 1
    v_add_u32_dpp v35, v35, v35 quad_perm:[1,0,3,2] row_mask:0xf bank_mask:0xf
    s_nop 1
    v_add_u32_dpp v35, v35, v35 quad_perm:[2,3,0,1] row_mask:0xf bank_mask:0xf
    s_nop 1
    v_add_u32_dpp v35, v35, v35 row_ror:4 row_mask:0xf bank_mask:0xf
    s_nop 1
    v_ashrrev_i32 v35, 3, v35
    v_add_u32 v35, s86, v35
    v_or_b32 v35, 1, v35
    ds_write_b32 v12, v35 offset:16
L_sp1:
    s_sub_u32 s58, s58, 1
    s_cbranch_scc1 L_giveup
    s_sleep 4
    ds_read_b32 v5, v12 offset:0
    s_waitcnt lgkmcnt(0)
    v_readfirstlane_b32 s94, v5
    s_nop 2
    s_cmp_ge_u32 s94, 4
    s_cbranch_scc0 L_sp1
    ds_read_b128 v[72:75], v36 offset:16384
    ds_read_b128 v[76:79], v36 offset:16640
    ds_read_b32 v27, v89 offset:17152
    s_waitcnt lgkmcnt(0)
    v_max3_f32 v80, v72, v73, v74
    v_max_f32 v80, v75, v80
    v_sub_f32 v72, v72, v80
    v_sub_f32 v73, v73, v80
    v_sub_f32 v74, v74, v80
    v_sub_f32 v75, v75, v80
    v_exp_f32 v72, v72
    v_exp_f32 v73, v73
    v_exp_f32 v74, v74
    v_exp_f32 v75, v75
    v_mov_b32 v82, s57
    v_mov_b32 v83, 0
    ds_write_b128 v36, v[72:75] offset:16896
    v_mul_f32 v81, v72, v76
    v_fmac_f32 v81, v73, v77
    v_fmac_f32 v81, v74, v78
    v_fmac_f32 v81, v75, v79
    v_min_u32 v80, s101, v80
    v_min_u32 v81, s101, v81
    s_setprio 3
    s_mov_b64 exec, 0xff
    buffer_store_dwordx4 v[80:83], v88, s[36:39], s93 offen sc1
    s_mov_b64 exec, -1
    s_setprio 0
    v_mul_f32 v27, 0x3e0293ee, v27
    v_add_f32 v27, v27, v26
L_sp2:
    s_sub_u32 s58, s58, 1
    s_cbranch_scc1 L_giveup
    s_sleep 4
    ds_read_b32 v5, v12 offset:4
    s_waitcnt lgkmcnt(0)
    v_readfirstlane_b32 s94, v5
    s_nop 2
    s_cmp_ge_u32 s94, 1
    s_cbranch_scc0 L_sp2
    s_setprio 3
    s_mov_b32 s88, 0
L_mlpoll:
    s_sub_u32 s58, s58, 1
    s_cbranch_scc1 L_giveup2
    buffer_load_dwordx4 v[56:59], v29, s[36:39], s65 offen sc1
    s_waitcnt vmcnt(0)
    v_max3_u32 v5, v56, v57, v58
    v_cmp_eq_u32 vcc, -1, v5
    s_cbranch_vccz L_mlgot
    s_cmp_eq_u32 s88, 0
    s_cbranch_scc0 L_mlpoll
    s_sleep 16
    ds_read_b32 v5, v12 offset:4
    s_waitcnt lgkmcnt(0)
    v_readfirstlane_b32 s95, v5
    s_nop 2
    s_cmp_le_u32 s95, 4
    s_cbranch_scc1 L_mlpoll
    s_barrier
    s_mov_b32 s88, 1
    s_branch L_mlpoll
L_mlgot:
    v_cmp_ne_u32 vcc, s57, v58
    v_max_f32 v33, v56, v27
    s_nop 0
    s_cmp_eq_u64 vcc, 0
    s_cselect_b32 s56, 1, 0
    v_mov_b32 v6, s56
    ds_write_b32 v12, v6 offset:8
    v_max_f32_dpp v33, v33, v33 quad_perm:[1,0,3,2] row_mask:0xf bank_mask:0xf
    s_nop 1
    v_max_f32_dpp v33, v33, v33 quad_perm:[2,3,0,1] row_mask:0xf bank_mask:0xf
    s_nop 1
    v_max_f32_dpp v33, v33, v33 row_ror:4 row_mask:0xf bank_mask:0xf
    s_nop 1
    v_max_f32_dpp v33, v33, v33 row_ror:8 row_mask:0xf bank_mask:0xf
    s_nop 1
    v_mov_b32 v72, v33
    s_nop 1
    v_permlane16_swap_b32 v33, v72
    s_nop 1
    v_max_f32 v33, v33, v72
    s_nop 1
    v_sub_f32 v65, v56, v33
    v_sub_f32 v64, v27, v33
    v_exp_f32 v65, v65
    v_exp_f32 v64, v64
    s_nop 0
    v_mul_f32 v34, v65, v57
    s_nop 1
    v_add_f32_dpp v34, v34, v34 quad_perm:[1,0,3,2] row_mask:0xf bank_mask:0xf
    s_nop 1
    v_add_f32_dpp v34, v34, v34 quad_perm:[2,3,0,1] row_mask:0xf bank_mask:0xf
    s_nop 1
    v_add_f32_dpp v34, v34, v34 row_ror:4 row_mask:0xf bank_mask:0xf
    s_nop 1
    v_add_f32_dpp v34, v34, v34 row_ror:8 row_mask:0xf bank_mask:0xf
    s_nop 1
    v_mov_b32 v72, v34
    s_nop 1
    v_permlane16_swap_b32 v34, v72
    s_nop 1
    v_add_f32 v34, v34, v72
    s_nop 1
    v_add_f32 v34, v34, v64
    v_rcp_f32 v34, v34
    s_nop 0
    v_mul_f32 v65, v65, v34
    v_mul_f32 v64, v64, v34
    ds_bpermute_b32 v60, v90, v65 offset:0
    ds_bpermute_b32 v61, v90, v65 offset:4
    ds_bpermute_b32 v62, v90, v65 offset:8
    ds_bpermute_b32 v63, v90, v65 offset:12
    v_mul_f32 v5, v64, v28
    v_mov_b32 v84, 0
    v_mov_b32 v85, 0
    v_mov_b32 v86, 0
    v_mov_b32 v87, 0
    s_mov_b64 exec, 0xff
    v_mov_b32 v84, v5
    s_mov_b64 exec, 0xff00
    v_mov_b32 v85, v5
    s_mov_b64 exec, 0xff0000
    v_mov_b32 v86, v5
    s_mov_b32 exec_lo, 0xff000000
    v_mov_b32 v87, v5
    s_mov_b64 exec, -1
    s_waitcnt lgkmcnt(0)
    s_lshr_b32 s94, s23, 2
    s_lshl_b32 s94, s94, 3
    s_lshl_b64 s[94:95], 1, s94
    s_cmp_eq_u32 s88, 0
    s_cselect_b64 s[94:95], s[94:95], -1
    s_cmp_eq_u32 s56, 1
    s_cselect_b64 exec, s[94:95], -1
    s_cmp_eq_u32 s56, 1
    s_cbranch_scc1 L_poll
    s_cmp_eq_u32 s88, 0
    s_cbranch_scc0 L_postbar
    s_barrier
    s_mov_b32 s88, 1
L_postbar:
L_sp4:
    s_sub_u32 s58, s58, 1
    s_cbranch_scc1 L_fin
    s_sleep 4
    ds_read_b32 v5, v12 offset:12
    s_waitcnt lgkmcnt(0)
    v_readfirstlane_b32 s94, v5
    s_nop 2
    s_cmp_ge_u32 s94, 4
    s_cbranch_scc0 L_sp4
    v_mov_b32 v5, 1
    s_mov_b64 exec, 1
    buffer_atomic_add v5, v30, s[96:99], s100 offen offset:4 sc1
    s_mov_b64 exec, -1
L_c2:
    s_sub_u32 s58, s58, 1
    s_cbranch_scc1 L_fin
    buffer_load_dword v35, v30, s[96:99], s100 offen offset:4 sc1
    s_waitcnt vmcnt(0)
    v_readfirstlane_b32 s94, v35
    s_nop 2
    s_cmp_ge_u32 s94, 32
    s_cbranch_scc0 L_c2
    s_add_u32 s64, s64, 0x100000
L_poll:
    buffer_load_dwordx4 v[40:43], v32, s[36:39], s64 offen offset:0 sc1
    buffer_load_dwordx4 v[44:47], v32, s[36:39], s64 offen offset:128 sc1
    buffer_load_dwordx4 v[48:51], v32, s[36:39], s64 offen offset:256 sc1
    buffer_load_dwordx4 v[52:55], v32, s[36:39], s64 offen offset:384 sc1
L_poll2:
    s_sub_u32 s58, s58, 1
    s_cbranch_scc1 L_giveup2
    buffer_load_dwordx4 v[96:99], v32, s[36:39], s64 offen offset:0 sc1
    buffer_load_dwordx4 v[100:103], v32, s[36:39], s64 offen offset:128 sc1
    buffer_load_dwordx4 v[104:107], v32, s[36:39], s64 offen offset:256 sc1
    buffer_load_dwordx4 v[108:111], v32, s[36:39], s64 offen offset:384 sc1
    s_waitcnt vmcnt(4)
    v_max3_u32 v5, v40, v41, v42
    v_max3_u32 v6, v43, v44, v45
    v_max3_u32 v5, v46, v47, v5
    v_max3_u32 v6, v48, v49, v6
    v_max3_u32 v5, v50, v51, v5
    v_max3_u32 v6, v52, v53, v6
    v_max3_u32 v5, v54, v55, v5
    v_max_u32 v5, v5, v6
    v_cmp_eq_u32 vcc, -1, v5
    v_pk_fma_f32 v[68:69], v[40:41], v[60:61], v[84:85] op_sel:[0,0,0] op_sel_hi:[1,0,1]
    v_pk_fma_f32 v[70:71], v[42:43], v[60:61], v[86:87] op_sel:[0,0,0] op_sel_hi:[1,0,1]
    v_pk_fma_f32 v[68:69], v[44:45], v[60:61], v[68:69] op_sel:[0,1,0] op_sel_hi:[1,1,1]
    v_pk_fma_f32 v[70:71], v[46:47], v[60:61], v[70:71] op_sel:[0,1,0] op_sel_hi:[1,1,1]
    v_pk_fma_f32 v[68:69], v[48:49], v[62:63], v[68:69] op_sel:[0,0,0] op_sel_hi:[1,0,1]
    v_pk_fma_f32 v[70:71], v[50:51], v[62:63], v[70:71] op_sel:[0,0,0] op_sel_hi:[1,0,1]
    v_pk_fma_f32 v[68:69], v[52:53], v[62:63], v[68:69] op_sel:[0,1,0] op_sel_hi:[1,1,1]
    v_pk_fma_f32 v[70:71], v[54:55], v[62:63], v[70:71] op_sel:[0,1,0] op_sel_hi:[1,1,1]
    s_nop 0
    v_permlane32_swap_b32 v68, v69
    v_permlane32_swap_b32 v70, v71
    v_add_f32 v68, v68, v69
    v_add_f32 v70, v70, v71
    s_nop 1
    v_permlane16_swap_b32 v68, v70
    v_add_f32 v68, v68, v70
    s_nop 1
    v_add_f32_dpp v68, v68, v68 row_ror:8 row_mask:0xf bank_mask:0xf
    v_cvt_pk_bf16_f32 v68, v68, v68
    s_cbranch_vccz L_done
    buffer_load_dwordx4 v[40:43], v32, s[36:39], s64 offen offset:0 sc1
    buffer_load_dwordx4 v[44:47], v32, s[36:39], s64 offen offset:128 sc1
    buffer_load_dwordx4 v[48:51], v32, s[36:39], s64 offen offset:256 sc1
    buffer_load_dwordx4 v[52:55], v32, s[36:39], s64 offen offset:384 sc1
    s_waitcnt vmcnt(4)
    v_max3_u32 v5, v96, v97, v98
    v_max3_u32 v6, v99, v100, v101
    v_max3_u32 v5, v102, v103, v5
    v_max3_u32 v6, v104, v105, v6
    v_max3_u32 v5, v106, v107, v5
    v_max3_u32 v6, v108, v109, v6
    v_max3_u32 v5, v110, v111, v5
    v_max_u32 v5, v5, v6
    v_cmp_eq_u32 vcc, -1, v5
    v_pk_fma_f32 v[68:69], v[96:97], v[60:61], v[84:85] op_sel:[0,0,0] op_sel_hi:[1,0,1]
    v_pk_fma_f32 v[70:71], v[98:99], v[60:61], v[86:87] op_sel:[0,0,0] op_sel_hi:[1,0,1]
    v_pk_fma_f32 v[68:69], v[100:101], v[60:61], v[68:69] op_sel:[0,1,0] op_sel_hi:[1,1,1]
    v_pk_fma_f32 v[70:71], v[102:103], v[60:61], v[70:71] op_sel:[0,1,0] op_sel_hi:[1,1,1]
    v_pk_fma_f32 v[68:69], v[104:105], v[62:63], v[68:69] op_sel:[0,0,0] op_sel_hi:[1,0,1]
    v_pk_fma_f32 v[70:71], v[106:107], v[62:63], v[70:71] op_sel:[0,0,0] op_sel_hi:[1,0,1]
    v_pk_fma_f32 v[68:69], v[108:109], v[62:63], v[68:69] op_sel:[0,1,0] op_sel_hi:[1,1,1]
    v_pk_fma_f32 v[70:71], v[110:111], v[62:63], v[70:71] op_sel:[0,1,0] op_sel_hi:[1,1,1]
    s_nop 0
    v_permlane32_swap_b32 v68, v69
    v_permlane32_swap_b32 v70, v71
    v_add_f32 v68, v68, v69
    v_add_f32 v70, v70, v71
    s_nop 1
    v_permlane16_swap_b32 v68, v70
    v_add_f32 v68, v68, v70
    s_nop 1
    v_add_f32_dpp v68, v68, v68 row_ror:8 row_mask:0xf bank_mask:0xf
    v_cvt_pk_bf16_f32 v68, v68, v68
    s_cbranch_vccz L_done
    s_cmp_eq_u32 s88, 0
    s_cbranch_scc0 L_poll2
    s_waitcnt vmcnt(0)
    s_mov_b64 exec, -1
L_sp5:
    s_sub_u32 s58, s58, 1
    s_cbranch_scc1 L_giveup2
    s_sleep 1
    ds_read_b32 v5, v12 offset:4
    s_waitcnt lgkmcnt(0)
    v_readfirstlane_b32 s94, v5
    s_nop 2
    s_cmp_ge_u32 s94, 5
    s_cbranch_scc0 L_sp5
    buffer_load_dwordx4 v[96:99], v32, s[36:39], s64 offen offset:0 sc1
    buffer_load_dwordx4 v[100:103], v32, s[36:39], s64 offen offset:128 sc1
    buffer_load_dwordx4 v[104:107], v32, s[36:39], s64 offen offset:256 sc1
    buffer_load_dwordx4 v[108:111], v32, s[36:39], s64 offen offset:384 sc1
    s_barrier
    s_mov_b32 s88, 1
    s_branch L_poll
L_done:
    buffer_store_short v68, v31, s[44:47], s66 offen
L_giveup2:
    s_cmp_eq_u32 s88, 0
    s_cbranch_scc0 L_fin
L_giveup:
    s_barrier
L_fin:
L_end:
    s_endpgm
.section .rodata,"a"
.p2align 6
.amdhsa_kernel standalone__tree_speculative_verify_tree_attention_over_candidate_token_tree__decode_kernel
  .amdhsa_next_free_vgpr 256
  .amdhsa_next_free_sgpr 102
  .amdhsa_accum_offset 256
  .amdhsa_group_segment_fixed_size 0
  .amdhsa_kernarg_size 72
  .amdhsa_user_sgpr_count 2
  .amdhsa_user_sgpr_kernarg_segment_ptr 1
  .amdhsa_system_sgpr_workgroup_id_x 1
  .amdhsa_float_denorm_mode_32 3
.end_amdhsa_kernel
```
